```python
import torch

def _softmax(x, axis=-1):
    return torch.softmax(x, dim=axis)

def _gelu(x):
    return torch.nn.functional.gelu(x, approximate='tanh')

def _silu(x):
    return torch.nn.functional.silu(x)

def _sigmoid(x):
    return torch.sigmoid(x)

def _layernorm(x, axis=-1, eps=1e-05):
    m = x.mean(dim=axis, keepdim=True)
    v = x.var(dim=axis, keepdim=True, unbiased=False)
    return (x - m) / torch.sqrt(v + eps)

def _scatter_add(tgt, idx, src, axis=0):
    return tgt.clone().index_add_(axis, idx, src)

def _segment_sum(src, seg, n):
    out = torch.zeros((n,) + src.shape[1:], dtype=src.dtype)
    return out.index_add_(0, seg, src)

def _pad(x, pw):
    flat = tuple((v for pair in reversed(pw) for v in pair))
    return torch.nn.functional.pad(x, flat)
kernel_name = 'standalone__dit_block__diffusion'

def setup_inputs():

    _w = lambda a: (lambda t: t.to(torch.bfloat16) if t.is_floating_point() else t)(torch.as_tensor(a))
    B, N, D = (2, 1024, 384)
    F = 4 * D
    return {'x': _w((lambda *s: torch.randn(*s, dtype=torch.bfloat16) * 0.05)(B, N, D)), 'c': _w((lambda *s: torch.randn(*s, dtype=torch.bfloat16) * 0.2)(B, D)), 'wqkv': _w((lambda *s: torch.randn(*s, dtype=torch.bfloat16) * 0.05)(D, 3 * D)), 'wo': _w((lambda *s: torch.randn(*s, dtype=torch.bfloat16) * 0.05)(D, D)), 'w_mod': _w((lambda *s: torch.randn(*s, dtype=torch.bfloat16) * 0.2)(D, 6 * D)), 'w_fc1': _w((lambda *s: torch.randn(*s, dtype=torch.bfloat16) * 0.05)(D, F)), 'w_fc2': _w((lambda *s: torch.randn(*s, dtype=torch.bfloat16) * 0.05)(F, D))}

def reference(x, c, wqkv, wo, w_mod, w_fc1, w_fc2):
    B, N, D = x.shape
    H = 2
    Dh = D // H
    mod = (_silu(c) @ w_mod).reshape(B, 6, 1, D)
    shift_a, scale_a, gate_a, shift_m, scale_m, gate_m = [mod[:, i] for i in range(6)]
    h = _layernorm(x, axis=-1) * (1 + scale_a) + shift_a
    qkv = (h @ wqkv).reshape(B, N, 3, H, Dh)
    q, k, v = (qkv[:, :, 0].clone(), qkv[:, :, 1].clone(), qkv[:, :, 2].clone())
    attn = _softmax(torch.einsum('bqhd,bkhd->bhqk', q, k) * Dh ** (-0.5), axis=-1)
    a = torch.einsum('bhqk,bkhd->bqhd', attn, v).reshape(B, N, D) @ wo
    x = x + gate_a * a
    h2 = _layernorm(x, axis=-1) * (1 + scale_m) + shift_m
    m = _gelu(h2 @ w_fc1) @ w_fc2
    return x + gate_m * m
```

```asm
; @launch kernel=mega_kernel grid=(256,1,1) block=(256,1,1) lds=152064
.amdgcn_target "amdgcn-amd-amdhsa--gfx950"
.text
.globl mega_kernel
.p2align 8
.type mega_kernel,@function
mega_kernel:
  s_load_dwordx2 s[84:85], s[0:1], 24
  s_load_dwordx4 s[88:91], s[0:1], 40
  s_load_dwordx2 s[36:37], s[0:1], 8
  s_load_dwordx2 s[92:93], s[0:1], 32
  s_cmp_ge_u32 s2, 256
  s_cbranch_scc1 mega_kernel_end
  v_cmp_gt_u32 vcc, 16, v0
  s_getpc_b64 s[40:41]
mega_kernel_pc:
  s_and_saveexec_b64 s[44:45], vcc
  s_cbranch_execz mega_kernel_nocode
  s_lshr_b32 s42, s2, 3
  s_lshl_b32 s42, s42, 7
  v_lshlrev_b32 v10, 12, v0
  v_add_u32 v10, s42, v10
  v_min_u32 v10, mega_kernel_end-mega_kernel_pc, v10
  v_mov_b32 v11, s41
  v_add_co_u32 v10, vcc, s40, v10
  s_nop 1
  v_addc_co_u32 v11, vcc, 0, v11, vcc
  global_load_dword v243, v[10:11], off
mega_kernel_nocode:
  s_mov_b64 exec, s[44:45]
  s_cmp_ge_u32 s2, 256
  s_cbranch_scc1 mega_kernel_end
  s_load_dwordx2 s[4:5], s[0:1], 0
  s_load_dwordx2 s[6:7], s[0:1], 72
  s_load_dwordx2 s[60:61], s[0:1], 56
  s_load_dwordx2 s[58:59], s[0:1], 64
  s_load_dwordx2 s[80:81], s[0:1], 16
  v_lshrrev_b32 v5, 6, v0
  v_and_b32 v1, 63, v0
  v_and_b32 v2, 15, v0
  v_readfirstlane_b32 s3, v5
  v_lshrrev_b32 v3, 4, v1
  v_lshlrev_b32 v4, 4, v1
  s_waitcnt lgkmcnt(0)
  s_mov_b32 s8, s4
  s_and_b32 s9, s5, 0xffff
  s_mov_b32 s10, 1572864
  s_mov_b32 s11, 0x20000
  s_mov_b32 s12, s6
  s_and_b32 s13, s7, 0xffff
  s_mov_b32 s14, 33554432
  s_mov_b32 s15, 0x20000
  s_mov_b32 s16, s60
  s_and_b32 s17, s61, 0xffff
  s_mov_b32 s18, 1572864
  s_mov_b32 s19, 0x20000
  s_mov_b32 s96, s58
  s_and_b32 s97, s59, 0xffff
  s_mov_b32 s98, 256
  s_mov_b32 s99, 0x20000
  s_mov_b32 s80, s80
  s_and_b32 s81, s81, 0xffff
  s_mov_b32 s82, 884736
  s_mov_b32 s83, 0x20000
  s_getreg_b32 s33, hwreg(HW_REG_XCC_ID, 0, 3)
  s_add_u32 s2, s2, 192
  s_and_b32 s2, s2, 255
  s_and_b32 s25, s2, 7
  s_lshr_b32 s26, s2, 3
  s_and_b32 s27, s26, 3
  s_lshl_b32 s20, s25, 2
  s_add_u32 s20, s20, s27
  s_lshr_b32 s21, s26, 2
  s_lshr_b32 s27, s25, 1
  s_lshl_b32 s20, s27, 3
  s_and_b32 s27, s26, 7
  s_add_u32 s20, s20, s27
  s_lshr_b32 s27, s26, 3
  s_and_b32 s28, s25, 1
  s_mul_i32 s28, s28, 3
  s_add_u32 s28, s28, s27
  s_cmp_ge_u32 s21, 6
  s_cselect_b32 s21, s21, s28
  s_cmp_ge_u32 s21, 6
  s_cbranch_scc0 mega_kernel_qkv
  s_sub_u32 s30, s2, 192
  s_mov_b32 s86, s88
  s_mov_b32 s87, s89
  s_mov_b32 s88, s90
  s_mov_b32 s89, s91
  s_mov_b32 s36, s36
  s_and_b32 s37, s37, 0xffff
  s_mov_b32 s38, 1536
  s_mov_b32 s39, 0x20000
  s_mov_b32 s92, s92
  s_and_b32 s93, s93, 0xffff
  s_mov_b32 s94, 1769472
  s_mov_b32 s95, 0x20000
  s_cmp_ge_u32 s30, 11
  s_cbranch_scc1 mega_kernel_nz
  v_lshlrev_b32 v6, 4, v0
  v_mov_b32 v8, 0
  v_mov_b32 v9, 0
  v_mov_b32 v10, 0
  v_mov_b32 v11, 0
  s_mov_b32 s40, 4096
  s_cmp_lt_u32 s30, 8
  s_cselect_b32 s40, 2752512, s40
  s_lshl_b32 s41, s30, 12
  s_add_u32 s40, s40, s41
  buffer_store_dwordx4 v[8:11], v6, s[12:15], s40 offen sc1
  s_nop 1
mega_kernel_nz:
  s_lshl_b32 s31, s30, 2
  s_add_u32 s31, s31, s3
  s_add_u32 s32, s31, 128
  s_min_u32 s32, s32, 323
  s_mov_b32 s34, s30
  v_lshrrev_b32 v15, 5, v1
  v_mul_u32_u24 v15, 3072, v15
  v_and_b32 v12, 30, v1
  v_lshl_add_u32 v15, v12, 2, v15
  s_min_u32 s35, s30, 23
  s_lshl_b32 s35, s35, 7
  s_add_u32 s35, s35, 0x5000
  buffer_load_dwordx2 v[224:225], v15, s[12:15], s35 offen sc1
mega_kernel_modl:
  s_mov_b32 s40, s34
  v_lshrrev_b32 v6, 2, v0
  v_and_b32 v7, 3, v0
  v_mul_u32_u24 v8, 4608, v6
  v_lshl_add_u32 v8, v7, 4, v8
  v_lshlrev_b32 v9, 1, v6
  s_lshl_b32 s41, s40, 6
  buffer_load_ushort v40, v9, s[36:39], 0 offen offset:0
  buffer_load_ushort v41, v9, s[36:39], 0 offen offset:128
  buffer_load_ushort v42, v9, s[36:39], 0 offen offset:256
  buffer_load_ushort v43, v9, s[36:39], 0 offen offset:384
  buffer_load_ushort v44, v9, s[36:39], 0 offen offset:512
  buffer_load_ushort v45, v9, s[36:39], 0 offen offset:640
  buffer_load_ushort v46, v9, s[36:39], 0 offen offset:768
  buffer_load_ushort v47, v9, s[36:39], 0 offen offset:896
  buffer_load_ushort v48, v9, s[36:39], 0 offen offset:1024
  buffer_load_ushort v49, v9, s[36:39], 0 offen offset:1152
  buffer_load_ushort v50, v9, s[36:39], 0 offen offset:1280
  buffer_load_ushort v51, v9, s[36:39], 0 offen offset:1408
  s_add_u32 s42, s41, 0
  buffer_load_dwordx4 v[16:19], v8, s[92:95], s42 offen
  s_add_u32 s42, s41, 294912
  buffer_load_dwordx4 v[20:23], v8, s[92:95], s42 offen
  s_add_u32 s42, s41, 589824
  buffer_load_dwordx4 v[24:27], v8, s[92:95], s42 offen
  s_add_u32 s42, s41, 884736
  buffer_load_dwordx4 v[28:31], v8, s[92:95], s42 offen
  s_add_u32 s42, s41, 1179648
  buffer_load_dwordx4 v[32:35], v8, s[92:95], s42 offen
  s_add_u32 s42, s41, 1474560
  buffer_load_dwordx4 v[36:39], v8, s[92:95], s42 offen
  s_cmp_lt_u32 s31, 180
  s_cselect_b32 s68, s86, s88
  s_cselect_b32 s69, s87, s89
  s_movk_i32 s56, 768
  s_cselect_b32 s73, 3072, s56
  s_cselect_b32 s74, 0, 1
  s_mov_b32 s56, 1540096
  s_cselect_b32 s75, 360448, s56
  s_cselect_b32 s57, 12, 48
  s_cselect_b32 s58, 19, 21
  s_movk_i32 s56, 180
  s_cselect_b32 s56, 36, s56
  s_mov_b32 s70, 1179648
  s_cmp_lt_u32 s31, 36
  s_cselect_b32 s68, s84, s68
  s_cselect_b32 s69, s85, s69
  s_cselect_b32 s73, 768, s73
  s_cselect_b32 s74, 1, s74
  s_cselect_b32 s75, 65536, s75
  s_cselect_b32 s56, 0, s56
  s_cselect_b32 s70, 294912, s70
  s_and_b32 s69, s69, 0xffff
  s_mov_b32 s71, 0x20000
  s_sub_u32 s56, s31, s56
  s_mul_i32 s55, s56, 43691
  s_lshr_b32 s55, s55, s58
  s_mul_i32 s54, s55, s57
  s_sub_u32 s56, s56, s54
  s_lshl_b32 s54, s54, 3
  s_add_u32 s54, s54, s56
  s_lshl_b32 s54, s54, 10
  s_add_u32 s75, s75, s54
  s_lshl_b32 s76, s57, 10
  s_mul_i32 s72, s56, s73
  s_lshl_b32 s72, s72, 5
  s_lshl_b32 s55, s55, 8
  s_add_u32 s72, s72, s55
  s_cmp_lt_u32 s32, 180
  s_cselect_b32 s20, s86, s88
  s_cselect_b32 s21, s87, s89
  s_movk_i32 s56, 768
  s_cselect_b32 s25, 3072, s56
  s_cselect_b32 s26, 0, 1
  s_mov_b32 s56, 1540096
  s_cselect_b32 s27, 360448, s56
  s_cselect_b32 s57, 12, 48
  s_cselect_b32 s58, 19, 21
  s_movk_i32 s56, 180
  s_cselect_b32 s56, 36, s56
  s_mov_b32 s22, 1179648
  s_cmp_lt_u32 s32, 36
  s_cselect_b32 s20, s84, s20
  s_cselect_b32 s21, s85, s21
  s_cselect_b32 s25, 768, s25
  s_cselect_b32 s26, 1, s26
  s_cselect_b32 s27, 65536, s27
  s_cselect_b32 s56, 0, s56
  s_cselect_b32 s22, 294912, s22
  s_and_b32 s21, s21, 0xffff
  s_mov_b32 s23, 0x20000
  s_sub_u32 s56, s32, s56
  s_mul_i32 s55, s56, 43691
  s_lshr_b32 s55, s55, s58
  s_mul_i32 s54, s55, s57
  s_sub_u32 s56, s56, s54
  s_lshl_b32 s54, s54, 3
  s_add_u32 s54, s54, s56
  s_lshl_b32 s54, s54, 10
  s_add_u32 s27, s27, s54
  s_lshl_b32 s28, s57, 10
  s_mul_i32 s24, s56, s25
  s_lshl_b32 s24, s24, 5
  s_lshl_b32 s55, s55, 8
  s_add_u32 s24, s24, s55
  s_cmp_lt_u32 s34, 24
  s_cbranch_scc1 mega_kernel_pc1
  s_cmp_ge_u32 s34, 56
  s_cbranch_scc1 mega_kernel_pb1
  s_sub_u32 s56, 3, s74
  s_lshl_b32 s56, s73, s56
  v_mul_lo_u32 v13, v3, s56
  v_lshl_add_u32 v13, v2, 4, v13
  s_mul_i32 s57, s74, 12
  s_mul_i32 s57, s57, s73
  s_mov_b32 s58, s72
  buffer_load_dwordx4 v[96:99], v13, s[68:71], s58 offen
  s_add_u32 s58, s58, s73
  buffer_load_dwordx4 v[100:103], v13, s[68:71], s58 offen
  s_add_u32 s58, s58, s73
  buffer_load_dwordx4 v[104:107], v13, s[68:71], s58 offen
  s_add_u32 s58, s58, s73
  buffer_load_dwordx4 v[108:111], v13, s[68:71], s58 offen
  s_add_u32 s58, s58, s73
  s_add_u32 s58, s58, s57
  buffer_load_dwordx4 v[112:115], v13, s[68:71], s58 offen
  s_add_u32 s58, s58, s73
  buffer_load_dwordx4 v[116:119], v13, s[68:71], s58 offen
  s_add_u32 s58, s58, s73
  buffer_load_dwordx4 v[120:123], v13, s[68:71], s58 offen
  s_add_u32 s58, s58, s73
  buffer_load_dwordx4 v[124:127], v13, s[68:71], s58 offen
  s_add_u32 s58, s58, s73
  s_sub_u32 s56, 3, s26
  s_lshl_b32 s56, s25, s56
  v_mul_lo_u32 v14, v3, s56
  v_lshl_add_u32 v14, v2, 4, v14
  s_mul_i32 s57, s26, 12
  s_mul_i32 s57, s57, s25
  s_mov_b32 s58, s24
  buffer_load_dwordx4 v[128:131], v14, s[20:23], s58 offen
  s_add_u32 s58, s58, s25
  buffer_load_dwordx4 v[132:135], v14, s[20:23], s58 offen
  s_add_u32 s58, s58, s25
  buffer_load_dwordx4 v[136:139], v14, s[20:23], s58 offen
  s_add_u32 s58, s58, s25
  buffer_load_dwordx4 v[140:143], v14, s[20:23], s58 offen
  s_add_u32 s58, s58, s25
  s_add_u32 s58, s58, s57
  buffer_load_dwordx4 v[144:147], v14, s[20:23], s58 offen
  s_add_u32 s58, s58, s25
  buffer_load_dwordx4 v[148:151], v14, s[20:23], s58 offen
  s_add_u32 s58, s58, s25
  buffer_load_dwordx4 v[152:155], v14, s[20:23], s58 offen
  s_add_u32 s58, s58, s25
  buffer_load_dwordx4 v[156:159], v14, s[20:23], s58 offen
  s_add_u32 s58, s58, s25
  s_waitcnt vmcnt(22)
  s_branch mega_kernel_pe1
mega_kernel_pb1:
  s_cmp_ge_u32 s34, 64
  s_cbranch_scc1 mega_kernel_pc1
  s_add_u32 s42, s41, 0
  buffer_load_dwordx4 v[96:99], v8, s[92:95], s42 offen offset:512
  s_add_u32 s42, s41, 294912
  buffer_load_dwordx4 v[100:103], v8, s[92:95], s42 offen offset:512
  s_add_u32 s42, s41, 589824
  buffer_load_dwordx4 v[104:107], v8, s[92:95], s42 offen offset:512
  s_add_u32 s42, s41, 884736
  buffer_load_dwordx4 v[108:111], v8, s[92:95], s42 offen offset:512
  s_add_u32 s42, s41, 1179648
  buffer_load_dwordx4 v[112:115], v8, s[92:95], s42 offen offset:512
  s_add_u32 s42, s41, 1474560
  buffer_load_dwordx4 v[116:119], v8, s[92:95], s42 offen offset:512
  s_waitcnt vmcnt(12)
  s_branch mega_kernel_pe1
mega_kernel_pc1:
  s_waitcnt vmcnt(6)
mega_kernel_pe1:
  v_mov_b32 v64, 0
  v_mov_b32 v65, 0
  v_mov_b32 v66, 0
  v_mov_b32 v67, 0
  v_mov_b32 v68, 0
  v_mov_b32 v69, 0
  v_mov_b32 v70, 0
  v_mov_b32 v71, 0
  v_mov_b32 v72, 0
  v_mov_b32 v73, 0
  v_mov_b32 v74, 0
  v_mov_b32 v75, 0
  v_mov_b32 v76, 0
  v_mov_b32 v77, 0
  v_mov_b32 v78, 0
  v_mov_b32 v79, 0
  v_lshlrev_b32 v40, 16, v40
  v_lshlrev_b32 v41, 16, v41
  v_lshlrev_b32 v42, 16, v42
  v_lshlrev_b32 v43, 16, v43
  v_lshlrev_b32 v44, 16, v44
  v_lshlrev_b32 v45, 16, v45
  v_lshlrev_b32 v46, 16, v46
  v_lshlrev_b32 v47, 16, v47
  v_lshlrev_b32 v48, 16, v48
  v_lshlrev_b32 v49, 16, v49
  v_lshlrev_b32 v50, 16, v50
  v_lshlrev_b32 v51, 16, v51
  v_mul_f32 v52, 0xbfb8aa3b, v40
  v_mul_f32 v53, 0xbfb8aa3b, v41
  v_mul_f32 v54, 0xbfb8aa3b, v42
  v_mul_f32 v55, 0xbfb8aa3b, v43
  v_mul_f32 v56, 0xbfb8aa3b, v44
  v_mul_f32 v57, 0xbfb8aa3b, v45
  v_mul_f32 v58, 0xbfb8aa3b, v46
  v_mul_f32 v59, 0xbfb8aa3b, v47
  v_mul_f32 v60, 0xbfb8aa3b, v48
  v_mul_f32 v61, 0xbfb8aa3b, v49
  v_mul_f32 v62, 0xbfb8aa3b, v50
  v_mul_f32 v63, 0xbfb8aa3b, v51
  v_exp_f32 v52, v52
  v_exp_f32 v53, v53
  v_exp_f32 v54, v54
  v_exp_f32 v55, v55
  v_exp_f32 v56, v56
  v_exp_f32 v57, v57
  v_exp_f32 v58, v58
  v_exp_f32 v59, v59
  v_exp_f32 v60, v60
  v_exp_f32 v61, v61
  v_exp_f32 v62, v62
  v_exp_f32 v63, v63
  s_nop 0
  v_add_f32 v52, 1.0, v52
  v_add_f32 v53, 1.0, v53
  v_add_f32 v54, 1.0, v54
  v_add_f32 v55, 1.0, v55
  v_add_f32 v56, 1.0, v56
  v_add_f32 v57, 1.0, v57
  v_add_f32 v58, 1.0, v58
  v_add_f32 v59, 1.0, v59
  v_add_f32 v60, 1.0, v60
  v_add_f32 v61, 1.0, v61
  v_add_f32 v62, 1.0, v62
  v_add_f32 v63, 1.0, v63
  v_rcp_f32 v52, v52
  v_rcp_f32 v53, v53
  v_rcp_f32 v54, v54
  v_rcp_f32 v55, v55
  v_rcp_f32 v56, v56
  v_rcp_f32 v57, v57
  v_rcp_f32 v58, v58
  v_rcp_f32 v59, v59
  v_rcp_f32 v60, v60
  v_rcp_f32 v61, v61
  v_rcp_f32 v62, v62
  v_rcp_f32 v63, v63
  s_nop 0
  v_mul_f32 v40, v40, v52
  v_mul_f32 v41, v41, v53
  v_mul_f32 v42, v42, v54
  v_mul_f32 v43, v43, v55
  v_mul_f32 v44, v44, v56
  v_mul_f32 v45, v45, v57
  v_mul_f32 v46, v46, v58
  v_mul_f32 v47, v47, v59
  v_mul_f32 v48, v48, v60
  v_mul_f32 v49, v49, v61
  v_mul_f32 v50, v50, v62
  v_mul_f32 v51, v51, v63
  v_cvt_pk_bf16_f32 v40, v40, v40
  v_cvt_pk_bf16_f32 v41, v41, v41
  v_cvt_pk_bf16_f32 v42, v42, v42
  v_cvt_pk_bf16_f32 v43, v43, v43
  v_cvt_pk_bf16_f32 v44, v44, v44
  v_cvt_pk_bf16_f32 v45, v45, v45
  v_cvt_pk_bf16_f32 v46, v46, v46
  v_cvt_pk_bf16_f32 v47, v47, v47
  v_cvt_pk_bf16_f32 v48, v48, v48
  v_cvt_pk_bf16_f32 v49, v49, v49
  v_cvt_pk_bf16_f32 v50, v50, v50
  v_cvt_pk_bf16_f32 v51, v51, v51
  v_lshlrev_b32 v40, 16, v40
  v_lshlrev_b32 v41, 16, v41
  v_lshlrev_b32 v42, 16, v42
  v_lshlrev_b32 v43, 16, v43
  v_lshlrev_b32 v44, 16, v44
  v_lshlrev_b32 v45, 16, v45
  v_lshlrev_b32 v46, 16, v46
  v_lshlrev_b32 v47, 16, v47
  v_lshlrev_b32 v48, 16, v48
  v_lshlrev_b32 v49, 16, v49
  v_lshlrev_b32 v50, 16, v50
  v_lshlrev_b32 v51, 16, v51
  s_cmp_lt_u32 s34, 24
  s_cbranch_scc1 mega_kernel_pc2
  s_cmp_ge_u32 s34, 56
  s_cbranch_scc1 mega_kernel_pb2
  s_waitcnt vmcnt(16)
  s_branch mega_kernel_pe2
mega_kernel_pb2:
  s_cmp_ge_u32 s34, 64
  s_cbranch_scc1 mega_kernel_pc2
  s_waitcnt vmcnt(6)
  s_branch mega_kernel_pe2
mega_kernel_pc2:
  s_waitcnt vmcnt(0)
mega_kernel_pe2:
  v_lshlrev_b32 v52, 16, v16
  v_and_b32 v53, 0xffff0000, v16
  v_fmac_f32 v64, v40, v52
  v_fmac_f32 v65, v40, v53
  v_fmac_f32 v72, v46, v52
  v_fmac_f32 v73, v46, v53
  v_lshlrev_b32 v52, 16, v17
  v_and_b32 v53, 0xffff0000, v17
  v_fmac_f32 v66, v40, v52
  v_fmac_f32 v67, v40, v53
  v_fmac_f32 v74, v46, v52
  v_fmac_f32 v75, v46, v53
  v_lshlrev_b32 v52, 16, v18
  v_and_b32 v53, 0xffff0000, v18
  v_fmac_f32 v68, v40, v52
  v_fmac_f32 v69, v40, v53
  v_fmac_f32 v76, v46, v52
  v_fmac_f32 v77, v46, v53
  v_lshlrev_b32 v52, 16, v19
  v_and_b32 v53, 0xffff0000, v19
  v_fmac_f32 v70, v40, v52
  v_fmac_f32 v71, v40, v53
  v_fmac_f32 v78, v46, v52
  v_fmac_f32 v79, v46, v53
  v_lshlrev_b32 v52, 16, v20
  v_and_b32 v53, 0xffff0000, v20
  v_fmac_f32 v64, v41, v52
  v_fmac_f32 v65, v41, v53
  v_fmac_f32 v72, v47, v52
  v_fmac_f32 v73, v47, v53
  v_lshlrev_b32 v52, 16, v21
  v_and_b32 v53, 0xffff0000, v21
  v_fmac_f32 v66, v41, v52
  v_fmac_f32 v67, v41, v53
  v_fmac_f32 v74, v47, v52
  v_fmac_f32 v75, v47, v53
  v_lshlrev_b32 v52, 16, v22
  v_and_b32 v53, 0xffff0000, v22
  v_fmac_f32 v68, v41, v52
  v_fmac_f32 v69, v41, v53
  v_fmac_f32 v76, v47, v52
  v_fmac_f32 v77, v47, v53
  v_lshlrev_b32 v52, 16, v23
  v_and_b32 v53, 0xffff0000, v23
  v_fmac_f32 v70, v41, v52
  v_fmac_f32 v71, v41, v53
  v_fmac_f32 v78, v47, v52
  v_fmac_f32 v79, v47, v53
  v_lshlrev_b32 v52, 16, v24
  v_and_b32 v53, 0xffff0000, v24
  v_fmac_f32 v64, v42, v52
  v_fmac_f32 v65, v42, v53
  v_fmac_f32 v72, v48, v52
  v_fmac_f32 v73, v48, v53
  v_lshlrev_b32 v52, 16, v25
  v_and_b32 v53, 0xffff0000, v25
  v_fmac_f32 v66, v42, v52
  v_fmac_f32 v67, v42, v53
  v_fmac_f32 v74, v48, v52
  v_fmac_f32 v75, v48, v53
  v_lshlrev_b32 v52, 16, v26
  v_and_b32 v53, 0xffff0000, v26
  v_fmac_f32 v68, v42, v52
  v_fmac_f32 v69, v42, v53
  v_fmac_f32 v76, v48, v52
  v_fmac_f32 v77, v48, v53
  v_lshlrev_b32 v52, 16, v27
  v_and_b32 v53, 0xffff0000, v27
  v_fmac_f32 v70, v42, v52
  v_fmac_f32 v71, v42, v53
  v_fmac_f32 v78, v48, v52
  v_fmac_f32 v79, v48, v53
  v_lshlrev_b32 v52, 16, v28
  v_and_b32 v53, 0xffff0000, v28
  v_fmac_f32 v64, v43, v52
  v_fmac_f32 v65, v43, v53
  v_fmac_f32 v72, v49, v52
  v_fmac_f32 v73, v49, v53
  v_lshlrev_b32 v52, 16, v29
  v_and_b32 v53, 0xffff0000, v29
  v_fmac_f32 v66, v43, v52
  v_fmac_f32 v67, v43, v53
  v_fmac_f32 v74, v49, v52
  v_fmac_f32 v75, v49, v53
  v_lshlrev_b32 v52, 16, v30
  v_and_b32 v53, 0xffff0000, v30
  v_fmac_f32 v68, v43, v52
  v_fmac_f32 v69, v43, v53
  v_fmac_f32 v76, v49, v52
  v_fmac_f32 v77, v49, v53
  v_lshlrev_b32 v52, 16, v31
  v_and_b32 v53, 0xffff0000, v31
  v_fmac_f32 v70, v43, v52
  v_fmac_f32 v71, v43, v53
  v_fmac_f32 v78, v49, v52
  v_fmac_f32 v79, v49, v53
  v_lshlrev_b32 v52, 16, v32
  v_and_b32 v53, 0xffff0000, v32
  v_fmac_f32 v64, v44, v52
  v_fmac_f32 v65, v44, v53
  v_fmac_f32 v72, v50, v52
  v_fmac_f32 v73, v50, v53
  v_lshlrev_b32 v52, 16, v33
  v_and_b32 v53, 0xffff0000, v33
  v_fmac_f32 v66, v44, v52
  v_fmac_f32 v67, v44, v53
  v_fmac_f32 v74, v50, v52
  v_fmac_f32 v75, v50, v53
  v_lshlrev_b32 v52, 16, v34
  v_and_b32 v53, 0xffff0000, v34
  v_fmac_f32 v68, v44, v52
  v_fmac_f32 v69, v44, v53
  v_fmac_f32 v76, v50, v52
  v_fmac_f32 v77, v50, v53
  v_lshlrev_b32 v52, 16, v35
  v_and_b32 v53, 0xffff0000, v35
  v_fmac_f32 v70, v44, v52
  v_fmac_f32 v71, v44, v53
  v_fmac_f32 v78, v50, v52
  v_fmac_f32 v79, v50, v53
  v_lshlrev_b32 v52, 16, v36
  v_and_b32 v53, 0xffff0000, v36
  v_fmac_f32 v64, v45, v52
  v_fmac_f32 v65, v45, v53
  v_fmac_f32 v72, v51, v52
  v_fmac_f32 v73, v51, v53
  v_lshlrev_b32 v52, 16, v37
  v_and_b32 v53, 0xffff0000, v37
  v_fmac_f32 v66, v45, v52
  v_fmac_f32 v67, v45, v53
  v_fmac_f32 v74, v51, v52
  v_fmac_f32 v75, v51, v53
  v_lshlrev_b32 v52, 16, v38
  v_and_b32 v53, 0xffff0000, v38
  v_fmac_f32 v68, v45, v52
  v_fmac_f32 v69, v45, v53
  v_fmac_f32 v76, v51, v52
  v_fmac_f32 v77, v51, v53
  v_lshlrev_b32 v52, 16, v39
  v_and_b32 v53, 0xffff0000, v39
  v_fmac_f32 v70, v45, v52
  v_fmac_f32 v71, v45, v53
  v_fmac_f32 v78, v51, v52
  v_fmac_f32 v79, v51, v53
  s_nop 1
  v_add_f32_dpp v80, v64, v64 row_ror:4 row_mask:0xf bank_mask:0xf
  v_add_f32_dpp v81, v65, v65 row_ror:4 row_mask:0xf bank_mask:0xf
  v_add_f32_dpp v82, v66, v66 row_ror:4 row_mask:0xf bank_mask:0xf
  v_add_f32_dpp v83, v67, v67 row_ror:4 row_mask:0xf bank_mask:0xf
  v_add_f32_dpp v84, v68, v68 row_ror:4 row_mask:0xf bank_mask:0xf
  v_add_f32_dpp v85, v69, v69 row_ror:4 row_mask:0xf bank_mask:0xf
  v_add_f32_dpp v86, v70, v70 row_ror:4 row_mask:0xf bank_mask:0xf
  v_add_f32_dpp v87, v71, v71 row_ror:4 row_mask:0xf bank_mask:0xf
  v_add_f32_dpp v88, v72, v72 row_ror:4 row_mask:0xf bank_mask:0xf
  v_add_f32_dpp v89, v73, v73 row_ror:4 row_mask:0xf bank_mask:0xf
  v_add_f32_dpp v90, v74, v74 row_ror:4 row_mask:0xf bank_mask:0xf
  v_add_f32_dpp v91, v75, v75 row_ror:4 row_mask:0xf bank_mask:0xf
  v_add_f32_dpp v92, v76, v76 row_ror:4 row_mask:0xf bank_mask:0xf
  v_add_f32_dpp v93, v77, v77 row_ror:4 row_mask:0xf bank_mask:0xf
  v_add_f32_dpp v94, v78, v78 row_ror:4 row_mask:0xf bank_mask:0xf
  v_add_f32_dpp v95, v79, v79 row_ror:4 row_mask:0xf bank_mask:0xf
  v_mov_b32 v64, v80
  v_mov_b32 v65, v81
  v_mov_b32 v66, v82
  v_mov_b32 v67, v83
  v_mov_b32 v68, v84
  v_mov_b32 v69, v85
  v_mov_b32 v70, v86
  v_mov_b32 v71, v87
  v_mov_b32 v72, v88
  v_mov_b32 v73, v89
  v_mov_b32 v74, v90
  v_mov_b32 v75, v91
  v_mov_b32 v76, v92
  v_mov_b32 v77, v93
  v_mov_b32 v78, v94
  v_mov_b32 v79, v95
  s_nop 1
  v_add_f32_dpp v80, v64, v64 row_ror:8 row_mask:0xf bank_mask:0xf
  v_add_f32_dpp v81, v65, v65 row_ror:8 row_mask:0xf bank_mask:0xf
  v_add_f32_dpp v82, v66, v66 row_ror:8 row_mask:0xf bank_mask:0xf
  v_add_f32_dpp v83, v67, v67 row_ror:8 row_mask:0xf bank_mask:0xf
  v_add_f32_dpp v84, v68, v68 row_ror:8 row_mask:0xf bank_mask:0xf
  v_add_f32_dpp v85, v69, v69 row_ror:8 row_mask:0xf bank_mask:0xf
  v_add_f32_dpp v86, v70, v70 row_ror:8 row_mask:0xf bank_mask:0xf
  v_add_f32_dpp v87, v71, v71 row_ror:8 row_mask:0xf bank_mask:0xf
  v_add_f32_dpp v88, v72, v72 row_ror:8 row_mask:0xf bank_mask:0xf
  v_add_f32_dpp v89, v73, v73 row_ror:8 row_mask:0xf bank_mask:0xf
  v_add_f32_dpp v90, v74, v74 row_ror:8 row_mask:0xf bank_mask:0xf
  v_add_f32_dpp v91, v75, v75 row_ror:8 row_mask:0xf bank_mask:0xf
  v_add_f32_dpp v92, v76, v76 row_ror:8 row_mask:0xf bank_mask:0xf
  v_add_f32_dpp v93, v77, v77 row_ror:8 row_mask:0xf bank_mask:0xf
  v_add_f32_dpp v94, v78, v78 row_ror:8 row_mask:0xf bank_mask:0xf
  v_add_f32_dpp v95, v79, v79 row_ror:8 row_mask:0xf bank_mask:0xf
  v_mov_b32 v64, v80
  v_mov_b32 v65, v81
  v_mov_b32 v66, v82
  v_mov_b32 v67, v83
  v_mov_b32 v68, v84
  v_mov_b32 v69, v85
  v_mov_b32 v70, v86
  v_mov_b32 v71, v87
  v_mov_b32 v72, v88
  v_mov_b32 v73, v89
  v_mov_b32 v74, v90
  v_mov_b32 v75, v91
  v_mov_b32 v76, v92
  v_mov_b32 v77, v93
  v_mov_b32 v78, v94
  v_mov_b32 v79, v95
  v_lshrrev_b32 v10, 4, v0
  v_lshlrev_b32 v10, 8, v10
  v_lshl_add_u32 v10, v7, 5, v10
  ds_write_b128 v10, v[64:67] offset:0
  ds_write_b128 v10, v[68:71] offset:16
  ds_write_b128 v10, v[72:75] offset:128
  ds_write_b128 v10, v[76:79] offset:144
  s_waitcnt lgkmcnt(0)
  s_barrier
  s_cmp_lg_u32 s3, 0
  s_cbranch_scc1 mega_kernel_moddone
  v_lshlrev_b32 v10, 2, v0
  ds_read_b32 v16, v10 offset:0
  ds_read_b32 v17, v10 offset:256
  ds_read_b32 v18, v10 offset:512
  ds_read_b32 v19, v10 offset:768
  ds_read_b32 v20, v10 offset:1024
  ds_read_b32 v21, v10 offset:1280
  ds_read_b32 v22, v10 offset:1536
  ds_read_b32 v23, v10 offset:1792
  ds_read_b32 v24, v10 offset:2048
  ds_read_b32 v25, v10 offset:2304
  ds_read_b32 v26, v10 offset:2560
  ds_read_b32 v27, v10 offset:2816
  ds_read_b32 v28, v10 offset:3072
  ds_read_b32 v29, v10 offset:3328
  ds_read_b32 v30, v10 offset:3584
  ds_read_b32 v31, v10 offset:3840
  s_waitcnt lgkmcnt(0)
  v_add_f32 v16, v16, v24
  v_add_f32 v17, v17, v25
  v_add_f32 v18, v18, v26
  v_add_f32 v19, v19, v27
  v_add_f32 v20, v20, v28
  v_add_f32 v21, v21, v29
  v_add_f32 v22, v22, v30
  v_add_f32 v23, v23, v31
  v_add_f32 v16, v16, v20
  v_add_f32 v17, v17, v21
  v_add_f32 v18, v18, v22
  v_add_f32 v19, v19, v23
  v_add_f32 v16, v16, v18
  v_add_f32 v17, v17, v19
  v_add_f32 v16, v16, v17
  v_cvt_pk_bf16_f32 v16, v16, v16
  v_lshlrev_b32 v16, 16, v16
  v_add_f32 v17, 1.0, v16
  v_cvt_pk_bf16_f32 v17, v17, v17
  v_lshlrev_b32 v17, 16, v17
  s_mul_i32 s42, s40, 43691
  s_lshr_b32 s42, s42, 19
  s_cmp_eq_u32 s42, 1
  s_cselect_b32 s43, 1, 0
  s_cmp_eq_u32 s42, 4
  s_cselect_b32 s43, 1, s43
  s_cmp_eq_u32 s43, 1
  s_cselect_b64 vcc, -1, 0
  v_cndmask_b32 v16, v16, v17, vcc
  v_lshrrev_b32 v11, 5, v0
  v_mul_u32_u24 v11, 9216, v11
  v_and_b32 v12, 31, v0
  v_lshl_add_u32 v11, v12, 2, v11
  s_lshl_b32 s42, s40, 7
  buffer_store_dword v16, v11, s[12:15], s42 offen sc1
  v_lshrrev_b32 v11, 1, v11
  s_lshr_b32 s42, s42, 1
  s_add_u32 s42, s42, 0xC000
  buffer_store_short_d16_hi v16, v11, s[12:15], s42 offen sc1
  s_cmp_ge_u32 s34, 24
  s_cbranch_scc1 mega_kernel_moddone
  s_nop 1
  v_mov_b32_dpp v17, v16 quad_perm:[1,1,3,3] row_mask:0xf bank_mask:0xf
  v_lshrrev_b32 v224, 16, v16
  v_or_b32 v224, v224, v17
  v_add_u32 v225, 1, v225
  s_mov_b32 exec_lo, 0x55555555
  s_mov_b32 exec_hi, 0x55555555
  buffer_store_dwordx2 v[224:225], v15, s[12:15], s35 offen sc1
  s_mov_b64 exec, -1
  s_sub_u32 s56, 3, s74
  s_lshl_b32 s56, s73, s56
  v_mul_lo_u32 v13, v3, s56
  v_lshl_add_u32 v13, v2, 4, v13
  s_mul_i32 s57, s74, 12
  s_mul_i32 s57, s57, s73
  s_mov_b32 s58, s72
  buffer_load_dwordx4 v[96:99], v13, s[68:71], s58 offen
  s_add_u32 s58, s58, s73
  buffer_load_dwordx4 v[100:103], v13, s[68:71], s58 offen
  s_add_u32 s58, s58, s73
  buffer_load_dwordx4 v[104:107], v13, s[68:71], s58 offen
  s_add_u32 s58, s58, s73
  buffer_load_dwordx4 v[108:111], v13, s[68:71], s58 offen
  s_add_u32 s58, s58, s73
  s_add_u32 s58, s58, s57
  buffer_load_dwordx4 v[112:115], v13, s[68:71], s58 offen
  s_add_u32 s58, s58, s73
  buffer_load_dwordx4 v[116:119], v13, s[68:71], s58 offen
  s_add_u32 s58, s58, s73
  buffer_load_dwordx4 v[120:123], v13, s[68:71], s58 offen
  s_add_u32 s58, s58, s73
  buffer_load_dwordx4 v[124:127], v13, s[68:71], s58 offen
  s_add_u32 s58, s58, s73
  s_waitcnt vmcnt(8)
  v_mov_b32 v10, 0
  v_mov_b32 v11, 1
  s_mov_b64 exec, 1
  buffer_atomic_add v11, v10, s[96:99], 0 offen offset:64 sc0 sc1
  s_waitcnt vmcnt(0)
  v_readfirstlane_b32 s56, v11
  v_mov_b32 v11, 1
  s_cmp_lg_u32 s56, 23
  s_cbranch_scc1 mega_kernel_moddone
  buffer_store_dword v11, v10, s[96:99], 0 offen offset:128 sc1
mega_kernel_moddone:
  s_mov_b64 exec, -1
  s_cmp_ge_u32 s34, 64
  s_cbranch_scc1 mega_kernel_m2
  s_cmp_lt_u32 s34, 24
  s_cselect_b32 s56, s3, 0
  s_cmp_eq_u32 s56, 0
  s_cbranch_scc1 mega_kernel_late
  s_sub_u32 s56, 3, s74
  s_lshl_b32 s56, s73, s56
  v_mul_lo_u32 v13, v3, s56
  v_lshl_add_u32 v13, v2, 4, v13
  s_mul_i32 s57, s74, 12
  s_mul_i32 s57, s57, s73
  s_mov_b32 s58, s72
  buffer_load_dwordx4 v[96:99], v13, s[68:71], s58 offen
  s_add_u32 s58, s58, s73
  buffer_load_dwordx4 v[100:103], v13, s[68:71], s58 offen
  s_add_u32 s58, s58, s73
  buffer_load_dwordx4 v[104:107], v13, s[68:71], s58 offen
  s_add_u32 s58, s58, s73
  buffer_load_dwordx4 v[108:111], v13, s[68:71], s58 offen
  s_add_u32 s58, s58, s73
  s_add_u32 s58, s58, s57
  buffer_load_dwordx4 v[112:115], v13, s[68:71], s58 offen
  s_add_u32 s58, s58, s73
  buffer_load_dwordx4 v[116:119], v13, s[68:71], s58 offen
  s_add_u32 s58, s58, s73
  buffer_load_dwordx4 v[120:123], v13, s[68:71], s58 offen
  s_add_u32 s58, s58, s73
  buffer_load_dwordx4 v[124:127], v13, s[68:71], s58 offen
  s_add_u32 s58, s58, s73
mega_kernel_late:
  s_cmp_lg_u32 s3, 0
  s_cbranch_scc1 mega_kernel_tki
  s_lshl_b32 s56, s33, 2
  v_mov_b32 v5, 1
  v_mov_b32 v10, 0
  s_mov_b64 exec, 1
  buffer_atomic_add v5, v10, s[96:99], s56 offen sc0 sc1
  s_mov_b64 exec, -1
mega_kernel_tki:
  s_cmp_ge_u32 s34, 56
  s_cbranch_scc1 mega_kernel_np2
  s_waitcnt vmcnt(0)
  v_lshrrev_b32 v7, 1, v2
  v_mul_u32_u24 v7, 1040, v7
  v_lshl_add_u32 v7, v3, 8, v7
  v_and_b32 v8, 1, v2
  v_lshl_add_u32 v7, v8, 7, v7
  s_mul_i32 s56, s3, 8320
  s_add_u32 s56, s56, 8192
  v_add_u32 v7, s56, v7
  v_add_u32 v8, s56, v4
  s_mov_b32 s47, 0x05040100
  s_mov_b32 s48, 0x07060302
  v_perm_b32 v160, v100, v96, s47
  v_perm_b32 v161, v108, v104, s47
  v_perm_b32 v162, v116, v112, s47
  v_perm_b32 v163, v124, v120, s47
  ds_write_b128 v7, v[160:163] offset:0
  v_perm_b32 v164, v100, v96, s48
  v_perm_b32 v165, v108, v104, s48
  v_perm_b32 v166, v116, v112, s48
  v_perm_b32 v167, v124, v120, s48
  ds_write_b128 v7, v[164:167] offset:16
  v_perm_b32 v168, v101, v97, s47
  v_perm_b32 v169, v109, v105, s47
  v_perm_b32 v170, v117, v113, s47
  v_perm_b32 v171, v125, v121, s47
  ds_write_b128 v7, v[168:171] offset:32
  v_perm_b32 v172, v101, v97, s48
  v_perm_b32 v173, v109, v105, s48
  v_perm_b32 v174, v117, v113, s48
  v_perm_b32 v175, v125, v121, s48
  ds_write_b128 v7, v[172:175] offset:48
  v_perm_b32 v176, v102, v98, s47
  v_perm_b32 v177, v110, v106, s47
  v_perm_b32 v178, v118, v114, s47
  v_perm_b32 v179, v126, v122, s47
  ds_write_b128 v7, v[176:179] offset:64
  v_perm_b32 v180, v102, v98, s48
  v_perm_b32 v181, v110, v106, s48
  v_perm_b32 v182, v118, v114, s48
  v_perm_b32 v183, v126, v122, s48
  ds_write_b128 v7, v[180:183] offset:80
  v_perm_b32 v184, v103, v99, s47
  v_perm_b32 v185, v111, v107, s47
  v_perm_b32 v186, v119, v115, s47
  v_perm_b32 v187, v127, v123, s47
  ds_write_b128 v7, v[184:187] offset:96
  v_perm_b32 v188, v103, v99, s48
  v_perm_b32 v189, v111, v107, s48
  v_perm_b32 v190, v119, v115, s48
  v_perm_b32 v191, v127, v123, s48
  ds_write_b128 v7, v[188:191] offset:112
  s_waitcnt lgkmcnt(0)
  ds_read_b128 v[96:99], v8 offset:0
  ds_read_b128 v[100:103], v8 offset:1040
  ds_read_b128 v[104:107], v8 offset:2080
  ds_read_b128 v[108:111], v8 offset:3120
  ds_read_b128 v[112:115], v8 offset:4160
  ds_read_b128 v[116:119], v8 offset:5200
  ds_read_b128 v[120:123], v8 offset:6240
  ds_read_b128 v[124:127], v8 offset:7280
  s_mov_b32 s56, s75
  s_waitcnt lgkmcnt(7)
  buffer_store_dwordx4 v[96:99], v4, s[12:15], s56 offen sc1
  s_add_u32 s56, s56, s76
  s_waitcnt lgkmcnt(6)
  buffer_store_dwordx4 v[100:103], v4, s[12:15], s56 offen sc1
  s_add_u32 s56, s56, s76
  s_waitcnt lgkmcnt(5)
  buffer_store_dwordx4 v[104:107], v4, s[12:15], s56 offen sc1
  s_add_u32 s56, s56, s76
  s_waitcnt lgkmcnt(4)
  buffer_store_dwordx4 v[108:111], v4, s[12:15], s56 offen sc1
  s_add_u32 s56, s56, s76
  s_waitcnt lgkmcnt(3)
  buffer_store_dwordx4 v[112:115], v4, s[12:15], s56 offen sc1
  s_add_u32 s56, s56, s76
  s_waitcnt lgkmcnt(2)
  buffer_store_dwordx4 v[116:119], v4, s[12:15], s56 offen sc1
  s_add_u32 s56, s56, s76
  s_waitcnt lgkmcnt(1)
  buffer_store_dwordx4 v[120:123], v4, s[12:15], s56 offen sc1
  s_add_u32 s56, s56, s76
  s_waitcnt lgkmcnt(0)
  buffer_store_dwordx4 v[124:127], v4, s[12:15], s56 offen sc1
  s_add_u32 s56, s56, s76
  s_sub_u32 s56, s31, 96
  s_cmp_ge_u32 s56, 100
  s_cbranch_scc1 mega_kernel_np2
  v_lshrrev_b32 v7, 1, v2
  v_mul_u32_u24 v7, 1040, v7
  v_lshl_add_u32 v7, v3, 8, v7
  v_and_b32 v8, 1, v2
  v_lshl_add_u32 v7, v8, 7, v7
  s_mul_i32 s56, s3, 8320
  s_add_u32 s56, s56, 8192
  v_add_u32 v7, s56, v7
  v_add_u32 v8, s56, v4
  s_mov_b32 s47, 0x05040100
  s_mov_b32 s48, 0x07060302
  v_perm_b32 v192, v132, v128, s47
  v_perm_b32 v193, v140, v136, s47
  v_perm_b32 v194, v148, v144, s47
  v_perm_b32 v195, v156, v152, s47
  ds_write_b128 v7, v[192:195] offset:0
  v_perm_b32 v196, v132, v128, s48
  v_perm_b32 v197, v140, v136, s48
  v_perm_b32 v198, v148, v144, s48
  v_perm_b32 v199, v156, v152, s48
  ds_write_b128 v7, v[196:199] offset:16
  v_perm_b32 v200, v133, v129, s47
  v_perm_b32 v201, v141, v137, s47
  v_perm_b32 v202, v149, v145, s47
  v_perm_b32 v203, v157, v153, s47
  ds_write_b128 v7, v[200:203] offset:32
  v_perm_b32 v204, v133, v129, s48
  v_perm_b32 v205, v141, v137, s48
  v_perm_b32 v206, v149, v145, s48
  v_perm_b32 v207, v157, v153, s48
  ds_write_b128 v7, v[204:207] offset:48
  v_perm_b32 v208, v134, v130, s47
  v_perm_b32 v209, v142, v138, s47
  v_perm_b32 v210, v150, v146, s47
  v_perm_b32 v211, v158, v154, s47
  ds_write_b128 v7, v[208:211] offset:64
  v_perm_b32 v212, v134, v130, s48
  v_perm_b32 v213, v142, v138, s48
  v_perm_b32 v214, v150, v146, s48
  v_perm_b32 v215, v158, v154, s48
  ds_write_b128 v7, v[212:215] offset:80
  v_perm_b32 v216, v135, v131, s47
  v_perm_b32 v217, v143, v139, s47
  v_perm_b32 v218, v151, v147, s47
  v_perm_b32 v219, v159, v155, s47
  ds_write_b128 v7, v[216:219] offset:96
  v_perm_b32 v220, v135, v131, s48
  v_perm_b32 v221, v143, v139, s48
  v_perm_b32 v222, v151, v147, s48
  v_perm_b32 v223, v159, v155, s48
  ds_write_b128 v7, v[220:223] offset:112
  s_waitcnt lgkmcnt(0)
  ds_read_b128 v[128:131], v8 offset:0
  ds_read_b128 v[132:135], v8 offset:1040
  ds_read_b128 v[136:139], v8 offset:2080
  ds_read_b128 v[140:143], v8 offset:3120
  ds_read_b128 v[144:147], v8 offset:4160
  ds_read_b128 v[148:151], v8 offset:5200
  ds_read_b128 v[152:155], v8 offset:6240
  ds_read_b128 v[156:159], v8 offset:7280
  s_mov_b32 s56, s27
  s_waitcnt lgkmcnt(7)
  buffer_store_dwordx4 v[128:131], v4, s[12:15], s56 offen sc1
  s_add_u32 s56, s56, s28
  s_waitcnt lgkmcnt(6)
  buffer_store_dwordx4 v[132:135], v4, s[12:15], s56 offen sc1
  s_add_u32 s56, s56, s28
  s_waitcnt lgkmcnt(5)
  buffer_store_dwordx4 v[136:139], v4, s[12:15], s56 offen sc1
  s_add_u32 s56, s56, s28
  s_waitcnt lgkmcnt(4)
  buffer_store_dwordx4 v[140:143], v4, s[12:15], s56 offen sc1
  s_add_u32 s56, s56, s28
  s_waitcnt lgkmcnt(3)
  buffer_store_dwordx4 v[144:147], v4, s[12:15], s56 offen sc1
  s_add_u32 s56, s56, s28
  s_waitcnt lgkmcnt(2)
  buffer_store_dwordx4 v[148:151], v4, s[12:15], s56 offen sc1
  s_add_u32 s56, s56, s28
  s_waitcnt lgkmcnt(1)
  buffer_store_dwordx4 v[152:155], v4, s[12:15], s56 offen sc1
  s_add_u32 s56, s56, s28
  s_waitcnt lgkmcnt(0)
  buffer_store_dwordx4 v[156:159], v4, s[12:15], s56 offen sc1
  s_add_u32 s56, s56, s28
mega_kernel_np2:
  s_waitcnt vmcnt(0)
  s_barrier
  s_cmp_lg_u32 s3, 0
  s_cbranch_scc1 mega_kernel_hd
  v_mov_b32 v10, 0
  v_mov_b32 v11, 1
  s_mov_b64 exec, 1
  buffer_atomic_add v11, v10, s[96:99], 0 offen offset:68 sc0 sc1
  s_waitcnt vmcnt(0)
  v_readfirstlane_b32 s56, v11
  v_mov_b32 v11, 1
  s_cmp_lg_u32 s56, 63
  s_cbranch_scc1 mega_kernel_hd
  buffer_store_dword v11, v10, s[96:99], 0 offen offset:132 sc1
mega_kernel_hd:
  s_mov_b64 exec, -1
  s_add_u32 s34, s34, 8
  s_cmp_ge_u32 s34, 64
  s_cbranch_scc1 mega_kernel_modl
  s_branch mega_kernel_m3
mega_kernel_m2:
  s_cmp_lg_u32 s3, 0
  s_cbranch_scc1 mega_kernel_m3
  s_waitcnt vmcnt(0)
  v_mov_b32 v10, 0
  v_mov_b32 v11, 1
  s_mov_b64 exec, 1
  buffer_atomic_add v11, v10, s[96:99], 0 offen offset:136 sc1
mega_kernel_m3:
  s_mov_b64 exec, -1
  s_cmp_lg_u32 s3, 0
  s_cbranch_scc1 mega_kernel_ddw
  v_mov_b32 v10, 128
  s_mov_b32 s57, 0x100000
mega_kernel_dlw:
  buffer_load_dword v11, v10, s[96:99], 0 offen sc1
  s_waitcnt vmcnt(0)
  v_cmp_ne_u32 vcc, 1, v11
  s_sub_u32 s57, s57, 1
  s_cbranch_scc1 mega_kernel_ddw
  s_cbranch_vccz mega_kernel_ddw
  s_sleep 2
  s_branch mega_kernel_dlw
mega_kernel_ddw:
  s_waitcnt vmcnt(0)
  s_branch mega_kernel_attn
mega_kernel_qkv:
  v_mul_u32_u24 v6, 768, v2
  v_lshl_add_u32 v6, v3, 4, v6
  s_mul_i32 s50, s3, 12288
  s_mul_i32 s46, s20, 49152
  s_add_u32 s50, s50, s46
  buffer_load_dwordx4 v[16:19], v6, s[8:11], s50 offen offset:0
  buffer_load_dwordx4 v[20:23], v6, s[8:11], s50 offen offset:64
  buffer_load_dwordx4 v[24:27], v6, s[8:11], s50 offen offset:128
  buffer_load_dwordx4 v[28:31], v6, s[8:11], s50 offen offset:192
  buffer_load_dwordx4 v[32:35], v6, s[8:11], s50 offen offset:256
  buffer_load_dwordx4 v[36:39], v6, s[8:11], s50 offen offset:320
  buffer_load_dwordx4 v[40:43], v6, s[8:11], s50 offen offset:384
  buffer_load_dwordx4 v[44:47], v6, s[8:11], s50 offen offset:448
  buffer_load_dwordx4 v[48:51], v6, s[8:11], s50 offen offset:512
  buffer_load_dwordx4 v[52:55], v6, s[8:11], s50 offen offset:576
  buffer_load_dwordx4 v[56:59], v6, s[8:11], s50 offen offset:640
  buffer_load_dwordx4 v[60:63], v6, s[8:11], s50 offen offset:704
  v_lshrrev_b32 v7, 3, v1
  v_mul_u32_u24 v8, 2304, v7
  v_and_b32 v9, 7, v1
  v_and_b32 v7, 2, v7
  v_xor_b32 v9, v9, v7
  v_xor_b32 v7, 4, v9
  v_lshl_add_u32 v12, v9, 4, v8
  v_lshl_add_u32 v13, v7, 4, v8
  s_mul_i32 s51, s3, 221184
  s_mul_i32 s52, s21, 384
  s_add_u32 s51, s51, s52
  s_mul_i32 s52, s3, 12288
  s_mov_b32 s55, 0x3f803f80
  s_mul_i32 s60, s33, 3
  s_lshr_b32 s60, s60, 2
  s_lshl_b32 s60, s60, 1
  s_lshr_b32 s53, s20, 4
  s_mul_i32 s53, s53, 3072
  s_min_u32 s54, s3, 2
  s_lshl_b32 s54, s54, 10
  s_add_u32 s53, s53, s54
  s_add_u32 s53, s53, 0x5000
  buffer_load_dwordx4 v[232:235], v4, s[12:15], s53 offen sc1
  s_lshl_b32 s44, s60, 10
  s_add_u32 s44, s44, s52
  s_mul_i32 s45, s60, 18432
  s_add_u32 s45, s45, s51
  s_add_u32 s60, s60, 1
  s_cmp_eq_u32 s60, 12
  s_cselect_b32 s60, 0, s60
  s_add_u32 m0, s44, 0
  s_add_u32 s59, s45, 0
  buffer_load_dwordx4 v12, s[80:83], s59 offen lds
  s_add_u32 m0, s44, 49152
  s_add_u32 s59, s45, 128
  buffer_load_dwordx4 v12, s[80:83], s59 offen lds
  s_add_u32 m0, s44, 98304
  s_add_u32 s59, s45, 256
  buffer_load_dwordx4 v12, s[80:83], s59 offen lds
  s_lshl_b32 s44, s60, 10
  s_add_u32 s44, s44, s52
  s_mul_i32 s45, s60, 18432
  s_add_u32 s45, s45, s51
  s_add_u32 s60, s60, 1
  s_cmp_eq_u32 s60, 12
  s_cselect_b32 s60, 0, s60
  s_add_u32 m0, s44, 0
  s_add_u32 s59, s45, 0
  buffer_load_dwordx4 v13, s[80:83], s59 offen lds
  s_add_u32 m0, s44, 49152
  s_add_u32 s59, s45, 128
  buffer_load_dwordx4 v13, s[80:83], s59 offen lds
  s_add_u32 m0, s44, 98304
  s_add_u32 s59, s45, 256
  buffer_load_dwordx4 v13, s[80:83], s59 offen lds
  s_lshl_b32 s44, s60, 10
  s_add_u32 s44, s44, s52
  s_mul_i32 s45, s60, 18432
  s_add_u32 s45, s45, s51
  s_add_u32 s60, s60, 1
  s_cmp_eq_u32 s60, 12
  s_cselect_b32 s60, 0, s60
  s_add_u32 m0, s44, 0
  s_add_u32 s59, s45, 0
  buffer_load_dwordx4 v12, s[80:83], s59 offen lds
  s_add_u32 m0, s44, 49152
  s_add_u32 s59, s45, 128
  buffer_load_dwordx4 v12, s[80:83], s59 offen lds
  s_add_u32 m0, s44, 98304
  s_add_u32 s59, s45, 256
  buffer_load_dwordx4 v12, s[80:83], s59 offen lds
  s_lshl_b32 s44, s60, 10
  s_add_u32 s44, s44, s52
  s_mul_i32 s45, s60, 18432
  s_add_u32 s45, s45, s51
  s_add_u32 s60, s60, 1
  s_cmp_eq_u32 s60, 12
  s_cselect_b32 s60, 0, s60
  s_add_u32 m0, s44, 0
  s_add_u32 s59, s45, 0
  buffer_load_dwordx4 v13, s[80:83], s59 offen lds
  s_add_u32 m0, s44, 49152
  s_add_u32 s59, s45, 128
  buffer_load_dwordx4 v13, s[80:83], s59 offen lds
  s_add_u32 m0, s44, 98304
  s_add_u32 s59, s45, 256
  buffer_load_dwordx4 v13, s[80:83], s59 offen lds
  s_lshl_b32 s44, s60, 10
  s_add_u32 s44, s44, s52
  s_mul_i32 s45, s60, 18432
  s_add_u32 s45, s45, s51
  s_add_u32 s60, s60, 1
  s_cmp_eq_u32 s60, 12
  s_cselect_b32 s60, 0, s60
  s_add_u32 m0, s44, 0
  s_add_u32 s59, s45, 0
  buffer_load_dwordx4 v12, s[80:83], s59 offen lds
  s_add_u32 m0, s44, 49152
  s_add_u32 s59, s45, 128
  buffer_load_dwordx4 v12, s[80:83], s59 offen lds
  s_add_u32 m0, s44, 98304
  s_add_u32 s59, s45, 256
  buffer_load_dwordx4 v12, s[80:83], s59 offen lds
  s_lshl_b32 s44, s60, 10
  s_add_u32 s44, s44, s52
  s_mul_i32 s45, s60, 18432
  s_add_u32 s45, s45, s51
  s_add_u32 s60, s60, 1
  s_cmp_eq_u32 s60, 12
  s_cselect_b32 s60, 0, s60
  s_add_u32 m0, s44, 0
  s_add_u32 s59, s45, 0
  buffer_load_dwordx4 v13, s[80:83], s59 offen lds
  s_add_u32 m0, s44, 49152
  s_add_u32 s59, s45, 128
  buffer_load_dwordx4 v13, s[80:83], s59 offen lds
  s_add_u32 m0, s44, 98304
  s_add_u32 s59, s45, 256
  buffer_load_dwordx4 v13, s[80:83], s59 offen lds
  v_mov_b32 v224, 0
  v_mov_b32 v225, 0
  v_mov_b32 v226, 0
  v_mov_b32 v227, 0
  v_mov_b32 v228, 0
  v_mov_b32 v229, 0
  v_mov_b32 v230, 0
  v_mov_b32 v231, 0
  s_waitcnt vmcnt(27)
  v_dot2c_f32_bf16 v224, s55, v16
  v_dot2c_f32_bf16 v228, v16, v16
  v_dot2c_f32_bf16 v225, s55, v17
  v_dot2c_f32_bf16 v229, v17, v17
  v_dot2c_f32_bf16 v226, s55, v18
  v_dot2c_f32_bf16 v230, v18, v18
  v_dot2c_f32_bf16 v227, s55, v19
  v_dot2c_f32_bf16 v231, v19, v19
  v_dot2c_f32_bf16 v224, s55, v20
  v_dot2c_f32_bf16 v228, v20, v20
  v_dot2c_f32_bf16 v225, s55, v21
  v_dot2c_f32_bf16 v229, v21, v21
  v_dot2c_f32_bf16 v226, s55, v22
  v_dot2c_f32_bf16 v230, v22, v22
  v_dot2c_f32_bf16 v227, s55, v23
  v_dot2c_f32_bf16 v231, v23, v23
  v_dot2c_f32_bf16 v224, s55, v24
  v_dot2c_f32_bf16 v228, v24, v24
  v_dot2c_f32_bf16 v225, s55, v25
  v_dot2c_f32_bf16 v229, v25, v25
  v_dot2c_f32_bf16 v226, s55, v26
  v_dot2c_f32_bf16 v230, v26, v26
  v_dot2c_f32_bf16 v227, s55, v27
  v_dot2c_f32_bf16 v231, v27, v27
  v_dot2c_f32_bf16 v224, s55, v28
  v_dot2c_f32_bf16 v228, v28, v28
  v_dot2c_f32_bf16 v225, s55, v29
  v_dot2c_f32_bf16 v229, v29, v29
  v_dot2c_f32_bf16 v226, s55, v30
  v_dot2c_f32_bf16 v230, v30, v30
  v_dot2c_f32_bf16 v227, s55, v31
  v_dot2c_f32_bf16 v231, v31, v31
  s_waitcnt vmcnt(23)
  v_dot2c_f32_bf16 v224, s55, v32
  v_dot2c_f32_bf16 v228, v32, v32
  v_dot2c_f32_bf16 v225, s55, v33
  v_dot2c_f32_bf16 v229, v33, v33
  v_dot2c_f32_bf16 v226, s55, v34
  v_dot2c_f32_bf16 v230, v34, v34
  v_dot2c_f32_bf16 v227, s55, v35
  v_dot2c_f32_bf16 v231, v35, v35
  v_dot2c_f32_bf16 v224, s55, v36
  v_dot2c_f32_bf16 v228, v36, v36
  v_dot2c_f32_bf16 v225, s55, v37
  v_dot2c_f32_bf16 v229, v37, v37
  v_dot2c_f32_bf16 v226, s55, v38
  v_dot2c_f32_bf16 v230, v38, v38
  v_dot2c_f32_bf16 v227, s55, v39
  v_dot2c_f32_bf16 v231, v39, v39
  v_dot2c_f32_bf16 v224, s55, v40
  v_dot2c_f32_bf16 v228, v40, v40
  v_dot2c_f32_bf16 v225, s55, v41
  v_dot2c_f32_bf16 v229, v41, v41
  v_dot2c_f32_bf16 v226, s55, v42
  v_dot2c_f32_bf16 v230, v42, v42
  v_dot2c_f32_bf16 v227, s55, v43
  v_dot2c_f32_bf16 v231, v43, v43
  v_dot2c_f32_bf16 v224, s55, v44
  v_dot2c_f32_bf16 v228, v44, v44
  v_dot2c_f32_bf16 v225, s55, v45
  v_dot2c_f32_bf16 v229, v45, v45
  v_dot2c_f32_bf16 v226, s55, v46
  v_dot2c_f32_bf16 v230, v46, v46
  v_dot2c_f32_bf16 v227, s55, v47
  v_dot2c_f32_bf16 v231, v47, v47
  s_waitcnt vmcnt(19)
  v_dot2c_f32_bf16 v224, s55, v48
  v_dot2c_f32_bf16 v228, v48, v48
  v_dot2c_f32_bf16 v225, s55, v49
  v_dot2c_f32_bf16 v229, v49, v49
  v_dot2c_f32_bf16 v226, s55, v50
  v_dot2c_f32_bf16 v230, v50, v50
  v_dot2c_f32_bf16 v227, s55, v51
  v_dot2c_f32_bf16 v231, v51, v51
  v_dot2c_f32_bf16 v224, s55, v52
  v_dot2c_f32_bf16 v228, v52, v52
  v_dot2c_f32_bf16 v225, s55, v53
  v_dot2c_f32_bf16 v229, v53, v53
  v_dot2c_f32_bf16 v226, s55, v54
  v_dot2c_f32_bf16 v230, v54, v54
  v_dot2c_f32_bf16 v227, s55, v55
  v_dot2c_f32_bf16 v231, v55, v55
  v_dot2c_f32_bf16 v224, s55, v56
  v_dot2c_f32_bf16 v228, v56, v56
  v_dot2c_f32_bf16 v225, s55, v57
  v_dot2c_f32_bf16 v229, v57, v57
  v_dot2c_f32_bf16 v226, s55, v58
  v_dot2c_f32_bf16 v230, v58, v58
  v_dot2c_f32_bf16 v227, s55, v59
  v_dot2c_f32_bf16 v231, v59, v59
  v_dot2c_f32_bf16 v224, s55, v60
  v_dot2c_f32_bf16 v228, v60, v60
  v_dot2c_f32_bf16 v225, s55, v61
  v_dot2c_f32_bf16 v229, v61, v61
  v_dot2c_f32_bf16 v226, s55, v62
  v_dot2c_f32_bf16 v230, v62, v62
  v_dot2c_f32_bf16 v227, s55, v63
  v_dot2c_f32_bf16 v231, v63, v63
  s_nop 2
  v_add_f32 v224, v224, v225
  v_add_f32 v226, v226, v227
  v_add_f32 v228, v228, v229
  v_add_f32 v230, v230, v231
  v_add_f32 v224, v224, v226
  v_add_f32 v225, v228, v230
  v_mov_b32 v226, v224
  v_mov_b32 v227, v225
  s_nop 1
  v_permlane16_swap_b32 v224, v226
  v_permlane16_swap_b32 v225, v227
  s_nop 1
  v_add_f32 v224, v224, v226
  v_add_f32 v225, v225, v227
  v_mov_b32 v226, v224
  v_mov_b32 v227, v225
  s_nop 1
  v_permlane32_swap_b32 v224, v226
  v_permlane32_swap_b32 v225, v227
  s_nop 1
  v_add_f32 v224, v224, v226
  v_add_f32 v225, v225, v227
  v_mul_f32 v224, 0x3b2aaaab, v224
  v_mul_f32 v225, 0x3b2aaaab, v225
  v_fma_f32 v225, -v224, v224, v225
  v_max_f32 v225, 0, v225
  v_add_f32 v225, 0x3727c5ac, v225
  v_rsq_f32 v226, v225
  s_nop 0
  v_mul_f32 v228, v224, v226
  v_sub_f32 v228, 0, v228
  s_lshl_b32 s44, s60, 10
  s_add_u32 s44, s44, s52
  s_mul_i32 s45, s60, 18432
  s_add_u32 s45, s45, s51
  s_add_u32 s60, s60, 1
  s_cmp_eq_u32 s60, 12
  s_cselect_b32 s60, 0, s60
  s_add_u32 m0, s44, 0
  s_add_u32 s59, s45, 0
  buffer_load_dwordx4 v12, s[80:83], s59 offen lds
  s_add_u32 m0, s44, 49152
  s_add_u32 s59, s45, 128
  buffer_load_dwordx4 v12, s[80:83], s59 offen lds
  s_add_u32 m0, s44, 98304
  s_add_u32 s59, s45, 256
  buffer_load_dwordx4 v12, s[80:83], s59 offen lds
  v_lshlrev_b32 v64, 16, v16
  v_and_b32 v65, 0xffff0000, v16
  v_lshlrev_b32 v66, 16, v17
  v_and_b32 v67, 0xffff0000, v17
  v_lshlrev_b32 v68, 16, v18
  v_and_b32 v69, 0xffff0000, v18
  v_lshlrev_b32 v70, 16, v19
  v_and_b32 v71, 0xffff0000, v19
  v_fma_f32 v64, v64, v226, v228
  v_fma_f32 v65, v65, v226, v228
  v_fma_f32 v66, v66, v226, v228
  v_fma_f32 v67, v67, v226, v228
  v_fma_f32 v68, v68, v226, v228
  v_fma_f32 v69, v69, v226, v228
  v_fma_f32 v70, v70, v226, v228
  v_fma_f32 v71, v71, v226, v228
  v_lshlrev_b32 v72, 16, v20
  v_and_b32 v73, 0xffff0000, v20
  v_lshlrev_b32 v74, 16, v21
  v_and_b32 v75, 0xffff0000, v21
  v_lshlrev_b32 v76, 16, v22
  v_and_b32 v77, 0xffff0000, v22
  v_lshlrev_b32 v78, 16, v23
  v_and_b32 v79, 0xffff0000, v23
  v_fma_f32 v72, v72, v226, v228
  v_fma_f32 v73, v73, v226, v228
  v_fma_f32 v74, v74, v226, v228
  v_fma_f32 v75, v75, v226, v228
  v_fma_f32 v76, v76, v226, v228
  v_fma_f32 v77, v77, v226, v228
  v_fma_f32 v78, v78, v226, v228
  v_fma_f32 v79, v79, v226, v228
  s_lshl_b32 s44, s60, 10
  s_add_u32 s44, s44, s52
  s_mul_i32 s45, s60, 18432
  s_add_u32 s45, s45, s51
  s_add_u32 s60, s60, 1
  s_cmp_eq_u32 s60, 12
  s_cselect_b32 s60, 0, s60
  s_add_u32 m0, s44, 0
  s_add_u32 s59, s45, 0
  buffer_load_dwordx4 v13, s[80:83], s59 offen lds
  s_add_u32 m0, s44, 49152
  s_add_u32 s59, s45, 128
  buffer_load_dwordx4 v13, s[80:83], s59 offen lds
  s_add_u32 m0, s44, 98304
  s_add_u32 s59, s45, 256
  buffer_load_dwordx4 v13, s[80:83], s59 offen lds
  v_lshlrev_b32 v80, 16, v24
  v_and_b32 v81, 0xffff0000, v24
  v_lshlrev_b32 v82, 16, v25
  v_and_b32 v83, 0xffff0000, v25
  v_lshlrev_b32 v84, 16, v26
  v_and_b32 v85, 0xffff0000, v26
  v_lshlrev_b32 v86, 16, v27
  v_and_b32 v87, 0xffff0000, v27
  v_fma_f32 v80, v80, v226, v228
  v_fma_f32 v81, v81, v226, v228
  v_fma_f32 v82, v82, v226, v228
  v_fma_f32 v83, v83, v226, v228
  v_fma_f32 v84, v84, v226, v228
  v_fma_f32 v85, v85, v226, v228
  v_fma_f32 v86, v86, v226, v228
  v_fma_f32 v87, v87, v226, v228
  v_lshlrev_b32 v88, 16, v28
  v_and_b32 v89, 0xffff0000, v28
  v_lshlrev_b32 v90, 16, v29
  v_and_b32 v91, 0xffff0000, v29
  v_lshlrev_b32 v92, 16, v30
  v_and_b32 v93, 0xffff0000, v30
  v_lshlrev_b32 v94, 16, v31
  v_and_b32 v95, 0xffff0000, v31
  v_fma_f32 v88, v88, v226, v228
  v_fma_f32 v89, v89, v226, v228
  v_fma_f32 v90, v90, v226, v228
  v_fma_f32 v91, v91, v226, v228
  v_fma_f32 v92, v92, v226, v228
  v_fma_f32 v93, v93, v226, v228
  v_fma_f32 v94, v94, v226, v228
  v_fma_f32 v95, v95, v226, v228
  s_lshl_b32 s44, s60, 10
  s_add_u32 s44, s44, s52
  s_mul_i32 s45, s60, 18432
  s_add_u32 s45, s45, s51
  s_add_u32 s60, s60, 1
  s_cmp_eq_u32 s60, 12
  s_cselect_b32 s60, 0, s60
  s_add_u32 m0, s44, 0
  s_add_u32 s59, s45, 0
  buffer_load_dwordx4 v12, s[80:83], s59 offen lds
  s_add_u32 m0, s44, 49152
  s_add_u32 s59, s45, 128
  buffer_load_dwordx4 v12, s[80:83], s59 offen lds
  s_add_u32 m0, s44, 98304
  s_add_u32 s59, s45, 256
  buffer_load_dwordx4 v12, s[80:83], s59 offen lds
  v_lshlrev_b32 v96, 16, v32
  v_and_b32 v97, 0xffff0000, v32
  v_lshlrev_b32 v98, 16, v33
  v_and_b32 v99, 0xffff0000, v33
  v_lshlrev_b32 v100, 16, v34
  v_and_b32 v101, 0xffff0000, v34
  v_lshlrev_b32 v102, 16, v35
  v_and_b32 v103, 0xffff0000, v35
  v_fma_f32 v96, v96, v226, v228
  v_fma_f32 v97, v97, v226, v228
  v_fma_f32 v98, v98, v226, v228
  v_fma_f32 v99, v99, v226, v228
  v_fma_f32 v100, v100, v226, v228
  v_fma_f32 v101, v101, v226, v228
  v_fma_f32 v102, v102, v226, v228
  v_fma_f32 v103, v103, v226, v228
  v_lshlrev_b32 v104, 16, v36
  v_and_b32 v105, 0xffff0000, v36
  v_lshlrev_b32 v106, 16, v37
  v_and_b32 v107, 0xffff0000, v37
  v_lshlrev_b32 v108, 16, v38
  v_and_b32 v109, 0xffff0000, v38
  v_lshlrev_b32 v110, 16, v39
  v_and_b32 v111, 0xffff0000, v39
  v_fma_f32 v104, v104, v226, v228
  v_fma_f32 v105, v105, v226, v228
  v_fma_f32 v106, v106, v226, v228
  v_fma_f32 v107, v107, v226, v228
  v_fma_f32 v108, v108, v226, v228
  v_fma_f32 v109, v109, v226, v228
  v_fma_f32 v110, v110, v226, v228
  v_fma_f32 v111, v111, v226, v228
  s_lshl_b32 s44, s60, 10
  s_add_u32 s44, s44, s52
  s_mul_i32 s45, s60, 18432
  s_add_u32 s45, s45, s51
  s_add_u32 s60, s60, 1
  s_cmp_eq_u32 s60, 12
  s_cselect_b32 s60, 0, s60
  s_add_u32 m0, s44, 0
  s_add_u32 s59, s45, 0
  buffer_load_dwordx4 v13, s[80:83], s59 offen lds
  s_add_u32 m0, s44, 49152
  s_add_u32 s59, s45, 128
  buffer_load_dwordx4 v13, s[80:83], s59 offen lds
  s_add_u32 m0, s44, 98304
  s_add_u32 s59, s45, 256
  buffer_load_dwordx4 v13, s[80:83], s59 offen lds
  v_lshlrev_b32 v112, 16, v40
  v_and_b32 v113, 0xffff0000, v40
  v_lshlrev_b32 v114, 16, v41
  v_and_b32 v115, 0xffff0000, v41
  v_lshlrev_b32 v116, 16, v42
  v_and_b32 v117, 0xffff0000, v42
  v_lshlrev_b32 v118, 16, v43
  v_and_b32 v119, 0xffff0000, v43
  v_fma_f32 v112, v112, v226, v228
  v_fma_f32 v113, v113, v226, v228
  v_fma_f32 v114, v114, v226, v228
  v_fma_f32 v115, v115, v226, v228
  v_fma_f32 v116, v116, v226, v228
  v_fma_f32 v117, v117, v226, v228
  v_fma_f32 v118, v118, v226, v228
  v_fma_f32 v119, v119, v226, v228
  v_lshlrev_b32 v120, 16, v44
  v_and_b32 v121, 0xffff0000, v44
  v_lshlrev_b32 v122, 16, v45
  v_and_b32 v123, 0xffff0000, v45
  v_lshlrev_b32 v124, 16, v46
  v_and_b32 v125, 0xffff0000, v46
  v_lshlrev_b32 v126, 16, v47
  v_and_b32 v127, 0xffff0000, v47
  v_fma_f32 v120, v120, v226, v228
  v_fma_f32 v121, v121, v226, v228
  v_fma_f32 v122, v122, v226, v228
  v_fma_f32 v123, v123, v226, v228
  v_fma_f32 v124, v124, v226, v228
  v_fma_f32 v125, v125, v226, v228
  v_fma_f32 v126, v126, v226, v228
  v_fma_f32 v127, v127, v226, v228
  s_lshl_b32 s44, s60, 10
  s_add_u32 s44, s44, s52
  s_mul_i32 s45, s60, 18432
  s_add_u32 s45, s45, s51
  s_add_u32 s60, s60, 1
  s_cmp_eq_u32 s60, 12
  s_cselect_b32 s60, 0, s60
  s_add_u32 m0, s44, 0
  s_add_u32 s59, s45, 0
  buffer_load_dwordx4 v12, s[80:83], s59 offen lds
  s_add_u32 m0, s44, 49152
  s_add_u32 s59, s45, 128
  buffer_load_dwordx4 v12, s[80:83], s59 offen lds
  s_add_u32 m0, s44, 98304
  s_add_u32 s59, s45, 256
  buffer_load_dwordx4 v12, s[80:83], s59 offen lds
  v_lshlrev_b32 v128, 16, v48
  v_and_b32 v129, 0xffff0000, v48
  v_lshlrev_b32 v130, 16, v49
  v_and_b32 v131, 0xffff0000, v49
  v_lshlrev_b32 v132, 16, v50
  v_and_b32 v133, 0xffff0000, v50
  v_lshlrev_b32 v134, 16, v51
  v_and_b32 v135, 0xffff0000, v51
  v_fma_f32 v128, v128, v226, v228
  v_fma_f32 v129, v129, v226, v228
  v_fma_f32 v130, v130, v226, v228
  v_fma_f32 v131, v131, v226, v228
  v_fma_f32 v132, v132, v226, v228
  v_fma_f32 v133, v133, v226, v228
  v_fma_f32 v134, v134, v226, v228
  v_fma_f32 v135, v135, v226, v228
  v_lshlrev_b32 v136, 16, v52
  v_and_b32 v137, 0xffff0000, v52
  v_lshlrev_b32 v138, 16, v53
  v_and_b32 v139, 0xffff0000, v53
  v_lshlrev_b32 v140, 16, v54
  v_and_b32 v141, 0xffff0000, v54
  v_lshlrev_b32 v142, 16, v55
  v_and_b32 v143, 0xffff0000, v55
  v_fma_f32 v136, v136, v226, v228
  v_fma_f32 v137, v137, v226, v228
  v_fma_f32 v138, v138, v226, v228
  v_fma_f32 v139, v139, v226, v228
  v_fma_f32 v140, v140, v226, v228
  v_fma_f32 v141, v141, v226, v228
  v_fma_f32 v142, v142, v226, v228
  v_fma_f32 v143, v143, v226, v228
  s_lshl_b32 s44, s60, 10
  s_add_u32 s44, s44, s52
  s_mul_i32 s45, s60, 18432
  s_add_u32 s45, s45, s51
  s_add_u32 s60, s60, 1
  s_cmp_eq_u32 s60, 12
  s_cselect_b32 s60, 0, s60
  s_add_u32 m0, s44, 0
  s_add_u32 s59, s45, 0
  buffer_load_dwordx4 v13, s[80:83], s59 offen lds
  s_add_u32 m0, s44, 49152
  s_add_u32 s59, s45, 128
  buffer_load_dwordx4 v13, s[80:83], s59 offen lds
  s_add_u32 m0, s44, 98304
  s_add_u32 s59, s45, 256
  buffer_load_dwordx4 v13, s[80:83], s59 offen lds
  v_lshlrev_b32 v144, 16, v56
  v_and_b32 v145, 0xffff0000, v56
  v_lshlrev_b32 v146, 16, v57
  v_and_b32 v147, 0xffff0000, v57
  v_lshlrev_b32 v148, 16, v58
  v_and_b32 v149, 0xffff0000, v58
  v_lshlrev_b32 v150, 16, v59
  v_and_b32 v151, 0xffff0000, v59
  v_fma_f32 v144, v144, v226, v228
  v_fma_f32 v145, v145, v226, v228
  v_fma_f32 v146, v146, v226, v228
  v_fma_f32 v147, v147, v226, v228
  v_fma_f32 v148, v148, v226, v228
  v_fma_f32 v149, v149, v226, v228
  v_fma_f32 v150, v150, v226, v228
  v_fma_f32 v151, v151, v226, v228
  v_lshlrev_b32 v152, 16, v60
  v_and_b32 v153, 0xffff0000, v60
  v_lshlrev_b32 v154, 16, v61
  v_and_b32 v155, 0xffff0000, v61
  v_lshlrev_b32 v156, 16, v62
  v_and_b32 v157, 0xffff0000, v62
  v_lshlrev_b32 v158, 16, v63
  v_and_b32 v159, 0xffff0000, v63
  v_fma_f32 v152, v152, v226, v228
  v_fma_f32 v153, v153, v226, v228
  v_fma_f32 v154, v154, v226, v228
  v_fma_f32 v155, v155, v226, v228
  v_fma_f32 v156, v156, v226, v228
  v_fma_f32 v157, v157, v226, v228
  v_fma_f32 v158, v158, v226, v228
  v_fma_f32 v159, v159, v226, v228
  buffer_load_dwordx4 v[236:239], v4, s[12:15], s53 offen sc1
  v_bfe_u32 v7, v1, 2, 2
  v_lshlrev_b32 v8, 7, v7
  v_lshl_add_u32 v8, v3, 10, v8
  v_and_b32 v9, 3, v1
  v_lshl_add_u32 v8, v9, 3, v8
  v_lshrrev_b32 v7, 1, v7
  v_and_b32 v9, 1, v3
  v_lshl_add_u32 v7, v9, 1, v7
  s_mul_i32 s56, s3, 3
  s_add_u32 s57, s56, 0
  s_and_b32 s58, s57, 3
  s_lshr_b32 s57, s57, 2
  s_mul_i32 s57, s57, 49152
  v_xor_b32 v9, s58, v7
  v_lshl_add_u32 v9, v9, 5, v8
  v_add_u32 v244, s57, v9
  s_add_u32 s57, s56, 1
  s_and_b32 s58, s57, 3
  s_lshr_b32 s57, s57, 2
  s_mul_i32 s57, s57, 49152
  v_xor_b32 v9, s58, v7
  v_lshl_add_u32 v9, v9, 5, v8
  v_add_u32 v245, s57, v9
  s_add_u32 s57, s56, 2
  s_and_b32 s58, s57, 3
  s_lshr_b32 s57, s57, 2
  s_mul_i32 s57, s57, 49152
  v_xor_b32 v9, s58, v7
  v_lshl_add_u32 v9, v9, 5, v8
  v_add_u32 v246, s57, v9
  v_mov_b32 v10, 128
  s_mov_b32 s57, 0x100000
  s_waitcnt vmcnt(0)
  s_branch mega_kernel_gc
mega_kernel_gl:
  s_sleep 3
  s_sub_u32 s57, s57, 1
  s_cbranch_scc1 mega_kernel_gd
  s_mov_b32 s56, 0
  s_and_b32 s58, s57, 3
  s_cbranch_scc1 mega_kernel_gn
  buffer_load_dword v11, v10, s[96:99], 0 offen sc1
  s_waitcnt vmcnt(0)
  v_readfirstlane_b32 s56, v11
mega_kernel_gn:
  buffer_load_dwordx4 v[236:239], v4, s[12:15], s53 offen sc1
  s_waitcnt vmcnt(0)
  s_cmp_eq_u32 s56, 1
  s_cbranch_scc1 mega_kernel_gd
mega_kernel_gc:
  v_cmp_eq_u32 vcc, v233, v237
  v_cmp_eq_u32 s[58:59], v235, v239
  s_or_b64 vcc, vcc, s[58:59]
  s_cbranch_vccnz mega_kernel_gl
mega_kernel_gd:
  v_lshlrev_b32 v240, 16, v236
  v_and_b32 v241, 0xffff0000, v236
  v_lshlrev_b32 v242, 16, v238
  v_and_b32 v243, 0xffff0000, v238
  s_add_u32 s54, s54, 147968
  v_add_u32 v10, s54, v4
  ds_write_b128 v10, v[240:243]
  s_cmp_lg_u32 s3, 0
  s_cbranch_scc1 mega_kernel_tkq
  s_lshl_b32 s56, s33, 2
  v_mov_b32 v5, 1
  v_mov_b32 v10, 0
  s_mov_b64 exec, 1
  buffer_atomic_add v5, v10, s[96:99], s56 offen sc0 sc1
  s_mov_b64 exec, -1
mega_kernel_tkq:
  s_waitcnt lgkmcnt(0)
  s_barrier
  s_lshr_b32 s47, s20, 4
  v_lshlrev_b32 v7, 5, v3
  v_add_u32 v7, 147968, v7
  s_mul_i32 s50, s3, 12288
  v_add_u32 v8, s50, v4
  ds_read_b128 v[160:163], v7 offset:0
  ds_read_b128 v[164:167], v7 offset:16
  ds_read_b128 v[168:171], v7 offset:1536
  ds_read_b128 v[172:175], v7 offset:1552
  ds_read_b128 v[176:179], v7 offset:128
  ds_read_b128 v[180:183], v7 offset:144
  ds_read_b128 v[184:187], v7 offset:1664
  ds_read_b128 v[188:191], v7 offset:1680
  s_waitcnt lgkmcnt(4)
  ds_read_b128 v[192:195], v7 offset:256
  ds_read_b128 v[196:199], v7 offset:272
  ds_read_b128 v[200:203], v7 offset:1792
  ds_read_b128 v[204:207], v7 offset:1808
  ds_read_b64_tr_b16 a[0:1], v244 offset:0
  ds_read_b64_tr_b16 a[2:3], v244 offset:512
  ds_read_b64_tr_b16 a[4:5], v245 offset:0
  ds_read_b64_tr_b16 a[6:7], v245 offset:512
  ds_read_b64_tr_b16 a[8:9], v246 offset:0
  ds_read_b64_tr_b16 a[10:11], v246 offset:512
  v_fma_f32 v64, v64, v168, v160
  v_fma_f32 v65, v65, v169, v161
  v_fma_f32 v66, v66, v170, v162
  v_fma_f32 v67, v67, v171, v163
  v_fma_f32 v68, v68, v172, v164
  v_fma_f32 v69, v69, v173, v165
  v_fma_f32 v70, v70, v174, v166
  v_fma_f32 v71, v71, v175, v167
  v_cvt_pk_bf16_f32 v16, v64, v65
  v_cvt_pk_bf16_f32 v17, v66, v67
  v_cvt_pk_bf16_f32 v18, v68, v69
  v_cvt_pk_bf16_f32 v19, v70, v71
  s_waitcnt lgkmcnt(10)
  ds_read_b128 v[160:163], v7 offset:384
  ds_read_b128 v[164:167], v7 offset:400
  ds_read_b128 v[168:171], v7 offset:1920
  ds_read_b128 v[172:175], v7 offset:1936
  ds_read_b64_tr_b16 a[12:13], v244 offset:4096
  ds_read_b64_tr_b16 a[14:15], v244 offset:4608
  ds_read_b64_tr_b16 a[16:17], v245 offset:4096
  ds_read_b64_tr_b16 a[18:19], v245 offset:4608
  ds_read_b64_tr_b16 a[20:21], v246 offset:4096
  ds_read_b64_tr_b16 a[22:23], v246 offset:4608
  v_fma_f32 v72, v72, v184, v176
  v_fma_f32 v73, v73, v185, v177
  v_fma_f32 v74, v74, v186, v178
  v_fma_f32 v75, v75, v187, v179
  v_fma_f32 v76, v76, v188, v180
  v_fma_f32 v77, v77, v189, v181
  v_fma_f32 v78, v78, v190, v182
  v_fma_f32 v79, v79, v191, v183
  v_cvt_pk_bf16_f32 v20, v72, v73
  v_cvt_pk_bf16_f32 v21, v74, v75
  v_cvt_pk_bf16_f32 v22, v76, v77
  v_cvt_pk_bf16_f32 v23, v78, v79
  s_waitcnt lgkmcnt(15)
  ds_read_b128 v[176:179], v7 offset:512
  ds_read_b128 v[180:183], v7 offset:528
  ds_read_b128 v[184:187], v7 offset:2048
  ds_read_b128 v[188:191], v7 offset:2064
  ds_read_b64_tr_b16 a[24:25], v244 offset:8192
  ds_read_b64_tr_b16 a[26:27], v244 offset:8704
  ds_read_b64_tr_b16 a[28:29], v245 offset:8192
  ds_read_b64_tr_b16 a[30:31], v245 offset:8704
  ds_read_b64_tr_b16 a[32:33], v246 offset:8192
  ds_read_b64_tr_b16 a[34:35], v246 offset:8704
  v_fma_f32 v80, v80, v200, v192
  v_fma_f32 v81, v81, v201, v193
  v_fma_f32 v82, v82, v202, v194
  v_fma_f32 v83, v83, v203, v195
  v_fma_f32 v84, v84, v204, v196
  v_fma_f32 v85, v85, v205, v197
  v_fma_f32 v86, v86, v206, v198
  v_fma_f32 v87, v87, v207, v199
  v_cvt_pk_bf16_f32 v24, v80, v81
  v_cvt_pk_bf16_f32 v25, v82, v83
  v_cvt_pk_bf16_f32 v26, v84, v85
  v_cvt_pk_bf16_f32 v27, v86, v87
  s_waitcnt lgkmcnt(15)
  ds_read_b128 v[192:195], v7 offset:640
  ds_read_b128 v[196:199], v7 offset:656
  ds_read_b128 v[200:203], v7 offset:2176
  ds_read_b128 v[204:207], v7 offset:2192
  ds_read_b64_tr_b16 a[36:37], v244 offset:12288
  ds_read_b64_tr_b16 a[38:39], v244 offset:12800
  ds_read_b64_tr_b16 a[40:41], v245 offset:12288
  ds_read_b64_tr_b16 a[42:43], v245 offset:12800
  ds_read_b64_tr_b16 a[44:45], v246 offset:12288
  ds_read_b64_tr_b16 a[46:47], v246 offset:12800
  v_fma_f32 v88, v88, v168, v160
  v_fma_f32 v89, v89, v169, v161
  v_fma_f32 v90, v90, v170, v162
  v_fma_f32 v91, v91, v171, v163
  v_fma_f32 v92, v92, v172, v164
  v_fma_f32 v93, v93, v173, v165
  v_fma_f32 v94, v94, v174, v166
  v_fma_f32 v95, v95, v175, v167
  v_cvt_pk_bf16_f32 v28, v88, v89
  v_cvt_pk_bf16_f32 v29, v90, v91
  v_cvt_pk_bf16_f32 v30, v92, v93
  v_cvt_pk_bf16_f32 v31, v94, v95
  s_waitcnt lgkmcnt(15)
  ds_read_b128 v[160:163], v7 offset:768
  ds_read_b128 v[164:167], v7 offset:784
  ds_read_b128 v[168:171], v7 offset:2304
  ds_read_b128 v[172:175], v7 offset:2320
  ds_read_b64_tr_b16 a[48:49], v244 offset:16384
  ds_read_b64_tr_b16 a[50:51], v244 offset:16896
  ds_read_b64_tr_b16 a[52:53], v245 offset:16384
  ds_read_b64_tr_b16 a[54:55], v245 offset:16896
  ds_read_b64_tr_b16 a[56:57], v246 offset:16384
  ds_read_b64_tr_b16 a[58:59], v246 offset:16896
  v_fma_f32 v96, v96, v184, v176
  v_fma_f32 v97, v97, v185, v177
  v_fma_f32 v98, v98, v186, v178
  v_fma_f32 v99, v99, v187, v179
  v_fma_f32 v100, v100, v188, v180
  v_fma_f32 v101, v101, v189, v181
  v_fma_f32 v102, v102, v190, v182
  v_fma_f32 v103, v103, v191, v183
  v_cvt_pk_bf16_f32 v32, v96, v97
  v_cvt_pk_bf16_f32 v33, v98, v99
  v_cvt_pk_bf16_f32 v34, v100, v101
  v_cvt_pk_bf16_f32 v35, v102, v103
  s_waitcnt lgkmcnt(15)
  ds_read_b128 v[176:179], v7 offset:896
  ds_read_b128 v[180:183], v7 offset:912
  ds_read_b128 v[184:187], v7 offset:2432
  ds_read_b128 v[188:191], v7 offset:2448
  ds_read_b64_tr_b16 a[60:61], v244 offset:20480
  ds_read_b64_tr_b16 a[62:63], v244 offset:20992
  ds_read_b64_tr_b16 a[64:65], v245 offset:20480
  ds_read_b64_tr_b16 a[66:67], v245 offset:20992
  ds_read_b64_tr_b16 a[68:69], v246 offset:20480
  ds_read_b64_tr_b16 a[70:71], v246 offset:20992
  v_fma_f32 v104, v104, v200, v192
  v_fma_f32 v105, v105, v201, v193
  v_fma_f32 v106, v106, v202, v194
  v_fma_f32 v107, v107, v203, v195
  v_fma_f32 v108, v108, v204, v196
  v_fma_f32 v109, v109, v205, v197
  v_fma_f32 v110, v110, v206, v198
  v_fma_f32 v111, v111, v207, v199
  v_cvt_pk_bf16_f32 v36, v104, v105
  v_cvt_pk_bf16_f32 v37, v106, v107
  v_cvt_pk_bf16_f32 v38, v108, v109
  v_cvt_pk_bf16_f32 v39, v110, v111
  s_waitcnt lgkmcnt(15)
  ds_read_b128 v[192:195], v7 offset:1024
  ds_read_b128 v[196:199], v7 offset:1040
  ds_read_b128 v[200:203], v7 offset:2560
  ds_read_b128 v[204:207], v7 offset:2576
  ds_read_b64_tr_b16 a[72:73], v244 offset:24576
  ds_read_b64_tr_b16 a[74:75], v244 offset:25088
  ds_read_b64_tr_b16 a[76:77], v245 offset:24576
  ds_read_b64_tr_b16 a[78:79], v245 offset:25088
  ds_read_b64_tr_b16 a[80:81], v246 offset:24576
  ds_read_b64_tr_b16 a[82:83], v246 offset:25088
  v_fma_f32 v112, v112, v168, v160
  v_fma_f32 v113, v113, v169, v161
  v_fma_f32 v114, v114, v170, v162
  v_fma_f32 v115, v115, v171, v163
  v_fma_f32 v116, v116, v172, v164
  v_fma_f32 v117, v117, v173, v165
  v_fma_f32 v118, v118, v174, v166
  v_fma_f32 v119, v119, v175, v167
  v_cvt_pk_bf16_f32 v40, v112, v113
  v_cvt_pk_bf16_f32 v41, v114, v115
  v_cvt_pk_bf16_f32 v42, v116, v117
  v_cvt_pk_bf16_f32 v43, v118, v119
  s_waitcnt lgkmcnt(15)
  ds_read_b128 v[160:163], v7 offset:1152
  ds_read_b128 v[164:167], v7 offset:1168
  ds_read_b128 v[168:171], v7 offset:2688
  ds_read_b128 v[172:175], v7 offset:2704
  ds_read_b64_tr_b16 a[84:85], v244 offset:28672
  ds_read_b64_tr_b16 a[86:87], v244 offset:29184
  ds_read_b64_tr_b16 a[88:89], v245 offset:28672
  ds_read_b64_tr_b16 a[90:91], v245 offset:29184
  ds_read_b64_tr_b16 a[92:93], v246 offset:28672
  ds_read_b64_tr_b16 a[94:95], v246 offset:29184
  v_fma_f32 v120, v120, v184, v176
  v_fma_f32 v121, v121, v185, v177
  v_fma_f32 v122, v122, v186, v178
  v_fma_f32 v123, v123, v187, v179
  v_fma_f32 v124, v124, v188, v180
  v_fma_f32 v125, v125, v189, v181
  v_fma_f32 v126, v126, v190, v182
  v_fma_f32 v127, v127, v191, v183
  v_cvt_pk_bf16_f32 v44, v120, v121
  v_cvt_pk_bf16_f32 v45, v122, v123
  v_cvt_pk_bf16_f32 v46, v124, v125
  v_cvt_pk_bf16_f32 v47, v126, v127
  s_waitcnt lgkmcnt(15)
  ds_read_b128 v[176:179], v7 offset:1280
  ds_read_b128 v[180:183], v7 offset:1296
  ds_read_b128 v[184:187], v7 offset:2816
  ds_read_b128 v[188:191], v7 offset:2832
  ds_read_b64_tr_b16 a[96:97], v244 offset:32768
  ds_read_b64_tr_b16 a[98:99], v244 offset:33280
  ds_read_b64_tr_b16 a[100:101], v245 offset:32768
  ds_read_b64_tr_b16 a[102:103], v245 offset:33280
  ds_read_b64_tr_b16 a[104:105], v246 offset:32768
  ds_read_b64_tr_b16 a[106:107], v246 offset:33280
  v_fma_f32 v128, v128, v200, v192
  v_fma_f32 v129, v129, v201, v193
  v_fma_f32 v130, v130, v202, v194
  v_fma_f32 v131, v131, v203, v195
  v_fma_f32 v132, v132, v204, v196
  v_fma_f32 v133, v133, v205, v197
  v_fma_f32 v134, v134, v206, v198
  v_fma_f32 v135, v135, v207, v199
  v_cvt_pk_bf16_f32 v48, v128, v129
  v_cvt_pk_bf16_f32 v49, v130, v131
  v_cvt_pk_bf16_f32 v50, v132, v133
  v_cvt_pk_bf16_f32 v51, v134, v135
  s_waitcnt lgkmcnt(15)
  ds_read_b128 v[192:195], v7 offset:1408
  ds_read_b128 v[196:199], v7 offset:1424
  ds_read_b128 v[200:203], v7 offset:2944
  ds_read_b128 v[204:207], v7 offset:2960
  ds_read_b64_tr_b16 a[108:109], v244 offset:36864
  ds_read_b64_tr_b16 a[110:111], v244 offset:37376
  ds_read_b64_tr_b16 a[112:113], v245 offset:36864
  ds_read_b64_tr_b16 a[114:115], v245 offset:37376
  ds_read_b64_tr_b16 a[116:117], v246 offset:36864
  ds_read_b64_tr_b16 a[118:119], v246 offset:37376
  v_fma_f32 v136, v136, v168, v160
  v_fma_f32 v137, v137, v169, v161
  v_fma_f32 v138, v138, v170, v162
  v_fma_f32 v139, v139, v171, v163
  v_fma_f32 v140, v140, v172, v164
  v_fma_f32 v141, v141, v173, v165
  v_fma_f32 v142, v142, v174, v166
  v_fma_f32 v143, v143, v175, v167
  v_cvt_pk_bf16_f32 v52, v136, v137
  v_cvt_pk_bf16_f32 v53, v138, v139
  v_cvt_pk_bf16_f32 v54, v140, v141
  v_cvt_pk_bf16_f32 v55, v142, v143
  s_waitcnt lgkmcnt(15)
  ds_read_b64_tr_b16 a[120:121], v244 offset:40960
  ds_read_b64_tr_b16 a[122:123], v244 offset:41472
  ds_read_b64_tr_b16 a[124:125], v245 offset:40960
  ds_read_b64_tr_b16 a[126:127], v245 offset:41472
  ds_read_b64_tr_b16 a[128:129], v246 offset:40960
  ds_read_b64_tr_b16 a[130:131], v246 offset:41472
  v_fma_f32 v144, v144, v184, v176
  v_fma_f32 v145, v145, v185, v177
  v_fma_f32 v146, v146, v186, v178
  v_fma_f32 v147, v147, v187, v179
  v_fma_f32 v148, v148, v188, v180
  v_fma_f32 v149, v149, v189, v181
  v_fma_f32 v150, v150, v190, v182
  v_fma_f32 v151, v151, v191, v183
  v_cvt_pk_bf16_f32 v56, v144, v145
  v_cvt_pk_bf16_f32 v57, v146, v147
  v_cvt_pk_bf16_f32 v58, v148, v149
  v_cvt_pk_bf16_f32 v59, v150, v151
  s_waitcnt lgkmcnt(12)
  ds_read_b64_tr_b16 a[132:133], v244 offset:45056
  ds_read_b64_tr_b16 a[134:135], v244 offset:45568
  ds_read_b64_tr_b16 a[136:137], v245 offset:45056
  ds_read_b64_tr_b16 a[138:139], v245 offset:45568
  ds_read_b64_tr_b16 a[140:141], v246 offset:45056
  ds_read_b64_tr_b16 a[142:143], v246 offset:45568
  v_fma_f32 v152, v152, v200, v192
  v_fma_f32 v153, v153, v201, v193
  v_fma_f32 v154, v154, v202, v194
  v_fma_f32 v155, v155, v203, v195
  v_fma_f32 v156, v156, v204, v196
  v_fma_f32 v157, v157, v205, v197
  v_fma_f32 v158, v158, v206, v198
  v_fma_f32 v159, v159, v207, v199
  v_cvt_pk_bf16_f32 v60, v152, v153
  v_cvt_pk_bf16_f32 v61, v154, v155
  v_cvt_pk_bf16_f32 v62, v156, v157
  v_cvt_pk_bf16_f32 v63, v158, v159
  s_waitcnt lgkmcnt(0)
  s_barrier
  ds_write_b128 v8, v[16:19] offset:0
  ds_write_b128 v8, v[20:23] offset:1024
  ds_write_b128 v8, v[24:27] offset:2048
  ds_write_b128 v8, v[28:31] offset:3072
  ds_write_b128 v8, v[32:35] offset:4096
  ds_write_b128 v8, v[36:39] offset:5120
  ds_write_b128 v8, v[40:43] offset:6144
  ds_write_b128 v8, v[44:47] offset:7168
  ds_write_b128 v8, v[48:51] offset:8192
  ds_write_b128 v8, v[52:55] offset:9216
  ds_write_b128 v8, v[56:59] offset:10240
  ds_write_b128 v8, v[60:63] offset:11264
  s_mul_i32 s56, s3, 3
  s_add_u32 s57, s56, 0
  s_lshr_b32 s58, s57, 1
  s_lshl_b32 s58, s58, 10
  s_and_b32 s57, s57, 1
  s_lshl_b32 s57, s57, 3
  s_add_u32 s58, s58, s57
  s_add_u32 s58, s58, 65536
  v_add_u32 v12, s58, v4
  s_add_u32 s57, s56, 1
  s_lshr_b32 s58, s57, 1
  s_lshl_b32 s58, s58, 10
  s_and_b32 s57, s57, 1
  s_lshl_b32 s57, s57, 3
  s_add_u32 s58, s58, s57
  s_add_u32 s58, s58, 65536
  v_add_u32 v13, s58, v4
  s_add_u32 s57, s56, 2
  s_lshr_b32 s58, s57, 1
  s_lshl_b32 s58, s58, 10
  s_and_b32 s57, s57, 1
  s_lshl_b32 s57, s57, 3
  s_add_u32 s58, s58, s57
  s_add_u32 s58, s58, 65536
  v_add_u32 v14, s58, v4
  s_mul_i32 s58, s3, 6144
  s_add_u32 s58, s58, 65536
  v_add_u32 v15, s58, v4
  s_waitcnt lgkmcnt(0)
  s_barrier
  s_and_b32 s27, s21, 1
  s_lshl_b32 s28, s47, 1
  s_add_u32 s27, s27, s28
  s_and_b32 s28, s20, 15
  s_lshl_b32 s29, s27, 4
  s_add_u32 s29, s29, s28
  s_mul_i32 s29, s29, 24576
  s_lshr_b32 s30, s21, 1
  s_mul_i32 s31, s30, 0x180000
  s_add_u32 s29, s29, s31
  s_add_u32 s29, s29, 4456448
  s_cmp_eq_u32 s30, 2
  s_cbranch_scc1 mega_kernel_v
  ds_read_b128 v[112:115], v4 offset:0
  ds_read_b128 v[116:119], v4 offset:1024
  ds_read_b128 v[120:123], v4 offset:2048
  ds_read_b128 v[124:127], v4 offset:3072
  ds_read_b128 v[128:131], v4 offset:4096
  ds_read_b128 v[132:135], v4 offset:5120
  ds_read_b128 v[136:139], v4 offset:6144
  s_waitcnt lgkmcnt(6)
  v_mfma_f32_16x16x32_bf16 v[64:67], a[0:3], v[112:115], 0
  v_mfma_f32_16x16x32_bf16 v[68:71], a[4:7], v[112:115], 0
  v_mfma_f32_16x16x32_bf16 v[72:75], a[8:11], v[112:115], 0
  ds_read_b128 v[140:143], v4 offset:7168
  s_waitcnt lgkmcnt(6)
  v_mfma_f32_16x16x32_bf16 v[64:67], a[12:15], v[116:119], v[64:67]
  v_mfma_f32_16x16x32_bf16 v[68:71], a[16:19], v[116:119], v[68:71]
  v_mfma_f32_16x16x32_bf16 v[72:75], a[20:23], v[116:119], v[72:75]
  ds_read_b128 v[112:115], v4 offset:8192
  s_waitcnt lgkmcnt(6)
  v_mfma_f32_16x16x32_bf16 v[64:67], a[24:27], v[120:123], v[64:67]
  v_mfma_f32_16x16x32_bf16 v[68:71], a[28:31], v[120:123], v[68:71]
  v_mfma_f32_16x16x32_bf16 v[72:75], a[32:35], v[120:123], v[72:75]
  ds_read_b128 v[116:119], v4 offset:9216
  s_waitcnt lgkmcnt(6)
  v_mfma_f32_16x16x32_bf16 v[64:67], a[36:39], v[124:127], v[64:67]
  v_mfma_f32_16x16x32_bf16 v[68:71], a[40:43], v[124:127], v[68:71]
  v_mfma_f32_16x16x32_bf16 v[72:75], a[44:47], v[124:127], v[72:75]
  ds_read_b128 v[120:123], v4 offset:10240
  s_waitcnt lgkmcnt(6)
  v_mfma_f32_16x16x32_bf16 v[64:67], a[48:51], v[128:131], v[64:67]
  v_mfma_f32_16x16x32_bf16 v[68:71], a[52:55], v[128:131], v[68:71]
  v_mfma_f32_16x16x32_bf16 v[72:75], a[56:59], v[128:131], v[72:75]
  ds_read_b128 v[124:127], v4 offset:11264
  s_waitcnt lgkmcnt(6)
  v_mfma_f32_16x16x32_bf16 v[64:67], a[60:63], v[132:135], v[64:67]
  v_mfma_f32_16x16x32_bf16 v[68:71], a[64:67], v[132:135], v[68:71]
  v_mfma_f32_16x16x32_bf16 v[72:75], a[68:71], v[132:135], v[72:75]
  ds_read_b128 v[128:131], v4 offset:12288
  s_waitcnt lgkmcnt(6)
  v_mfma_f32_16x16x32_bf16 v[64:67], a[72:75], v[136:139], v[64:67]
  v_mfma_f32_16x16x32_bf16 v[68:71], a[76:79], v[136:139], v[68:71]
  v_mfma_f32_16x16x32_bf16 v[72:75], a[80:83], v[136:139], v[72:75]
  ds_read_b128 v[132:135], v4 offset:13312
  s_waitcnt lgkmcnt(6)
  v_mfma_f32_16x16x32_bf16 v[64:67], a[84:87], v[140:143], v[64:67]
  v_mfma_f32_16x16x32_bf16 v[68:71], a[88:91], v[140:143], v[68:71]
  v_mfma_f32_16x16x32_bf16 v[72:75], a[92:95], v[140:143], v[72:75]
  ds_read_b128 v[136:139], v4 offset:14336
  s_waitcnt lgkmcnt(6)
  v_mfma_f32_16x16x32_bf16 v[64:67], a[96:99], v[112:115], v[64:67]
  v_mfma_f32_16x16x32_bf16 v[68:71], a[100:103], v[112:115], v[68:71]
  v_mfma_f32_16x16x32_bf16 v[72:75], a[104:107], v[112:115], v[72:75]
  ds_read_b128 v[140:143], v4 offset:15360
  s_waitcnt lgkmcnt(6)
  v_mfma_f32_16x16x32_bf16 v[64:67], a[108:111], v[116:119], v[64:67]
  v_mfma_f32_16x16x32_bf16 v[68:71], a[112:115], v[116:119], v[68:71]
  v_mfma_f32_16x16x32_bf16 v[72:75], a[116:119], v[116:119], v[72:75]
  ds_read_b128 v[112:115], v4 offset:16384
  s_waitcnt lgkmcnt(6)
  v_mfma_f32_16x16x32_bf16 v[64:67], a[120:123], v[120:123], v[64:67]
  v_mfma_f32_16x16x32_bf16 v[68:71], a[124:127], v[120:123], v[68:71]
  v_mfma_f32_16x16x32_bf16 v[72:75], a[128:131], v[120:123], v[72:75]
  ds_read_b128 v[116:119], v4 offset:17408
  s_waitcnt lgkmcnt(6)
  v_mfma_f32_16x16x32_bf16 v[64:67], a[132:135], v[124:127], v[64:67]
  v_mfma_f32_16x16x32_bf16 v[68:71], a[136:139], v[124:127], v[68:71]
  v_mfma_f32_16x16x32_bf16 v[72:75], a[140:143], v[124:127], v[72:75]
  ds_read_b128 v[120:123], v4 offset:18432
  s_waitcnt lgkmcnt(6)
  v_mfma_f32_16x16x32_bf16 v[76:79], a[0:3], v[128:131], 0
  v_mfma_f32_16x16x32_bf16 v[80:83], a[4:7], v[128:131], 0
  v_mfma_f32_16x16x32_bf16 v[84:87], a[8:11], v[128:131], 0
  ds_read_b128 v[124:127], v4 offset:19456
  s_waitcnt lgkmcnt(6)
  v_mfma_f32_16x16x32_bf16 v[76:79], a[12:15], v[132:135], v[76:79]
  v_mfma_f32_16x16x32_bf16 v[80:83], a[16:19], v[132:135], v[80:83]
  v_mfma_f32_16x16x32_bf16 v[84:87], a[20:23], v[132:135], v[84:87]
  ds_read_b128 v[128:131], v4 offset:20480
  s_waitcnt lgkmcnt(6)
  v_mfma_f32_16x16x32_bf16 v[76:79], a[24:27], v[136:139], v[76:79]
  v_mfma_f32_16x16x32_bf16 v[80:83], a[28:31], v[136:139], v[80:83]
  v_mfma_f32_16x16x32_bf16 v[84:87], a[32:35], v[136:139], v[84:87]
  ds_read_b128 v[132:135], v4 offset:21504
  s_waitcnt lgkmcnt(6)
  v_mfma_f32_16x16x32_bf16 v[76:79], a[36:39], v[140:143], v[76:79]
  v_cvt_pk_bf16_f32 v64, v64, v65
  v_mfma_f32_16x16x32_bf16 v[80:83], a[40:43], v[140:143], v[80:83]
  v_cvt_pk_bf16_f32 v65, v66, v67
  v_mfma_f32_16x16x32_bf16 v[84:87], a[44:47], v[140:143], v[84:87]
  ds_write_b64 v12, v[64:65] offset:0
  ds_read_b128 v[136:139], v4 offset:22528
  s_waitcnt lgkmcnt(7)
  v_mfma_f32_16x16x32_bf16 v[76:79], a[48:51], v[112:115], v[76:79]
  v_cvt_pk_bf16_f32 v68, v68, v69
  v_mfma_f32_16x16x32_bf16 v[80:83], a[52:55], v[112:115], v[80:83]
  v_cvt_pk_bf16_f32 v69, v70, v71
  v_mfma_f32_16x16x32_bf16 v[84:87], a[56:59], v[112:115], v[84:87]
  ds_write_b64 v13, v[68:69] offset:0
  ds_read_b128 v[140:143], v4 offset:23552
  s_waitcnt lgkmcnt(8)
  v_mfma_f32_16x16x32_bf16 v[76:79], a[60:63], v[116:119], v[76:79]
  v_cvt_pk_bf16_f32 v72, v72, v73
  v_mfma_f32_16x16x32_bf16 v[80:83], a[64:67], v[116:119], v[80:83]
  v_cvt_pk_bf16_f32 v73, v74, v75
  v_mfma_f32_16x16x32_bf16 v[84:87], a[68:71], v[116:119], v[84:87]
  ds_write_b64 v14, v[72:73] offset:0
  ds_read_b128 v[112:115], v4 offset:24576
  s_waitcnt lgkmcnt(9)
  v_mfma_f32_16x16x32_bf16 v[76:79], a[72:75], v[120:123], v[76:79]
  v_mfma_f32_16x16x32_bf16 v[80:83], a[76:79], v[120:123], v[80:83]
  v_mfma_f32_16x16x32_bf16 v[84:87], a[80:83], v[120:123], v[84:87]
  ds_read_b128 v[116:119], v4 offset:25600
  s_waitcnt lgkmcnt(9)
  v_mfma_f32_16x16x32_bf16 v[76:79], a[84:87], v[124:127], v[76:79]
  v_mfma_f32_16x16x32_bf16 v[80:83], a[88:91], v[124:127], v[80:83]
  v_mfma_f32_16x16x32_bf16 v[84:87], a[92:95], v[124:127], v[84:87]
  ds_read_b128 v[120:123], v4 offset:26624
  s_waitcnt lgkmcnt(9)
  v_mfma_f32_16x16x32_bf16 v[76:79], a[96:99], v[128:131], v[76:79]
  v_mfma_f32_16x16x32_bf16 v[80:83], a[100:103], v[128:131], v[80:83]
  v_mfma_f32_16x16x32_bf16 v[84:87], a[104:107], v[128:131], v[84:87]
  ds_read_b128 v[124:127], v4 offset:27648
  s_waitcnt lgkmcnt(9)
  v_mfma_f32_16x16x32_bf16 v[76:79], a[108:111], v[132:135], v[76:79]
  v_mfma_f32_16x16x32_bf16 v[80:83], a[112:115], v[132:135], v[80:83]
  v_mfma_f32_16x16x32_bf16 v[84:87], a[116:119], v[132:135], v[84:87]
  ds_read_b128 v[128:131], v4 offset:28672
  s_waitcnt lgkmcnt(8)
  v_mfma_f32_16x16x32_bf16 v[76:79], a[120:123], v[136:139], v[76:79]
  v_mfma_f32_16x16x32_bf16 v[80:83], a[124:127], v[136:139], v[80:83]
  v_mfma_f32_16x16x32_bf16 v[84:87], a[128:131], v[136:139], v[84:87]
  ds_read_b128 v[132:135], v4 offset:29696
  s_waitcnt lgkmcnt(7)
  v_mfma_f32_16x16x32_bf16 v[76:79], a[132:135], v[140:143], v[76:79]
  v_mfma_f32_16x16x32_bf16 v[80:83], a[136:139], v[140:143], v[80:83]
  v_mfma_f32_16x16x32_bf16 v[84:87], a[140:143], v[140:143], v[84:87]
  ds_read_b128 v[136:139], v4 offset:30720
  s_waitcnt lgkmcnt(6)
  v_mfma_f32_16x16x32_bf16 v[88:91], a[0:3], v[112:115], 0
  v_mfma_f32_16x16x32_bf16 v[92:95], a[4:7], v[112:115], 0
  v_mfma_f32_16x16x32_bf16 v[96:99], a[8:11], v[112:115], 0
  ds_read_b128 v[140:143], v4 offset:31744
  s_waitcnt lgkmcnt(6)
  v_mfma_f32_16x16x32_bf16 v[88:91], a[12:15], v[116:119], v[88:91]
  v_mfma_f32_16x16x32_bf16 v[92:95], a[16:19], v[116:119], v[92:95]
  v_mfma_f32_16x16x32_bf16 v[96:99], a[20:23], v[116:119], v[96:99]
  ds_read_b128 v[112:115], v4 offset:32768
  s_waitcnt lgkmcnt(6)
  v_mfma_f32_16x16x32_bf16 v[88:91], a[24:27], v[120:123], v[88:91]
  v_mfma_f32_16x16x32_bf16 v[92:95], a[28:31], v[120:123], v[92:95]
  v_mfma_f32_16x16x32_bf16 v[96:99], a[32:35], v[120:123], v[96:99]
  ds_read_b128 v[116:119], v4 offset:33792
  s_waitcnt lgkmcnt(6)
  v_mfma_f32_16x16x32_bf16 v[88:91], a[36:39], v[124:127], v[88:91]
  v_cvt_pk_bf16_f32 v76, v76, v77
  v_mfma_f32_16x16x32_bf16 v[92:95], a[40:43], v[124:127], v[92:95]
  v_cvt_pk_bf16_f32 v77, v78, v79
  v_mfma_f32_16x16x32_bf16 v[96:99], a[44:47], v[124:127], v[96:99]
  ds_write_b64 v12, v[76:77] offset:6144
  ds_read_b128 v[120:123], v4 offset:34816
  s_waitcnt lgkmcnt(7)
  v_mfma_f32_16x16x32_bf16 v[88:91], a[48:51], v[128:131], v[88:91]
  v_cvt_pk_bf16_f32 v80, v80, v81
  v_mfma_f32_16x16x32_bf16 v[92:95], a[52:55], v[128:131], v[92:95]
  v_cvt_pk_bf16_f32 v81, v82, v83
  v_mfma_f32_16x16x32_bf16 v[96:99], a[56:59], v[128:131], v[96:99]
  ds_write_b64 v13, v[80:81] offset:6144
  ds_read_b128 v[124:127], v4 offset:35840
  s_waitcnt lgkmcnt(8)
  v_mfma_f32_16x16x32_bf16 v[88:91], a[60:63], v[132:135], v[88:91]
  v_cvt_pk_bf16_f32 v84, v84, v85
  v_mfma_f32_16x16x32_bf16 v[92:95], a[64:67], v[132:135], v[92:95]
  v_cvt_pk_bf16_f32 v85, v86, v87
  v_mfma_f32_16x16x32_bf16 v[96:99], a[68:71], v[132:135], v[96:99]
  ds_write_b64 v14, v[84:85] offset:6144
  ds_read_b128 v[128:131], v4 offset:36864
  s_waitcnt lgkmcnt(9)
  v_mfma_f32_16x16x32_bf16 v[88:91], a[72:75], v[136:139], v[88:91]
  v_mfma_f32_16x16x32_bf16 v[92:95], a[76:79], v[136:139], v[92:95]
  v_mfma_f32_16x16x32_bf16 v[96:99], a[80:83], v[136:139], v[96:99]
  ds_read_b128 v[132:135], v4 offset:37888
  s_waitcnt lgkmcnt(9)
  v_mfma_f32_16x16x32_bf16 v[88:91], a[84:87], v[140:143], v[88:91]
  v_mfma_f32_16x16x32_bf16 v[92:95], a[88:91], v[140:143], v[92:95]
  v_mfma_f32_16x16x32_bf16 v[96:99], a[92:95], v[140:143], v[96:99]
  ds_read_b128 v[136:139], v4 offset:38912
  s_waitcnt lgkmcnt(9)
  v_mfma_f32_16x16x32_bf16 v[88:91], a[96:99], v[112:115], v[88:91]
  v_mfma_f32_16x16x32_bf16 v[92:95], a[100:103], v[112:115], v[92:95]
  v_mfma_f32_16x16x32_bf16 v[96:99], a[104:107], v[112:115], v[96:99]
  ds_read_b128 v[140:143], v4 offset:39936
  s_waitcnt lgkmcnt(9)
  v_mfma_f32_16x16x32_bf16 v[88:91], a[108:111], v[116:119], v[88:91]
  v_mfma_f32_16x16x32_bf16 v[92:95], a[112:115], v[116:119], v[92:95]
  v_mfma_f32_16x16x32_bf16 v[96:99], a[116:119], v[116:119], v[96:99]
  ds_read_b128 v[112:115], v4 offset:40960
  s_waitcnt lgkmcnt(8)
  v_mfma_f32_16x16x32_bf16 v[88:91], a[120:123], v[120:123], v[88:91]
  v_mfma_f32_16x16x32_bf16 v[92:95], a[124:127], v[120:123], v[92:95]
  v_mfma_f32_16x16x32_bf16 v[96:99], a[128:131], v[120:123], v[96:99]
  ds_read_b128 v[116:119], v4 offset:41984
  s_waitcnt lgkmcnt(7)
  v_mfma_f32_16x16x32_bf16 v[88:91], a[132:135], v[124:127], v[88:91]
  v_mfma_f32_16x16x32_bf16 v[92:95], a[136:139], v[124:127], v[92:95]
  v_mfma_f32_16x16x32_bf16 v[96:99], a[140:143], v[124:127], v[96:99]
  ds_read_b128 v[120:123], v4 offset:43008
  s_waitcnt lgkmcnt(6)
  v_mfma_f32_16x16x32_bf16 v[100:103], a[0:3], v[128:131], 0
  v_mfma_f32_16x16x32_bf16 v[104:107], a[4:7], v[128:131], 0
  v_mfma_f32_16x16x32_bf16 v[108:111], a[8:11], v[128:131], 0
  ds_read_b128 v[124:127], v4 offset:44032
  s_waitcnt lgkmcnt(6)
  v_mfma_f32_16x16x32_bf16 v[100:103], a[12:15], v[132:135], v[100:103]
  v_mfma_f32_16x16x32_bf16 v[104:107], a[16:19], v[132:135], v[104:107]
  v_mfma_f32_16x16x32_bf16 v[108:111], a[20:23], v[132:135], v[108:111]
  ds_read_b128 v[128:131], v4 offset:45056
  s_waitcnt lgkmcnt(6)
  v_mfma_f32_16x16x32_bf16 v[100:103], a[24:27], v[136:139], v[100:103]
  v_mfma_f32_16x16x32_bf16 v[104:107], a[28:31], v[136:139], v[104:107]
  v_mfma_f32_16x16x32_bf16 v[108:111], a[32:35], v[136:139], v[108:111]
  ds_read_b128 v[132:135], v4 offset:46080
  s_waitcnt lgkmcnt(6)
  v_mfma_f32_16x16x32_bf16 v[100:103], a[36:39], v[140:143], v[100:103]
  v_cvt_pk_bf16_f32 v88, v88, v89
  v_mfma_f32_16x16x32_bf16 v[104:107], a[40:43], v[140:143], v[104:107]
  v_cvt_pk_bf16_f32 v89, v90, v91
  v_mfma_f32_16x16x32_bf16 v[108:111], a[44:47], v[140:143], v[108:111]
  ds_write_b64 v12, v[88:89] offset:12288
  ds_read_b128 v[136:139], v4 offset:47104
  s_waitcnt lgkmcnt(7)
  v_mfma_f32_16x16x32_bf16 v[100:103], a[48:51], v[112:115], v[100:103]
  v_cvt_pk_bf16_f32 v92, v92, v93
  v_mfma_f32_16x16x32_bf16 v[104:107], a[52:55], v[112:115], v[104:107]
  v_cvt_pk_bf16_f32 v93, v94, v95
  v_mfma_f32_16x16x32_bf16 v[108:111], a[56:59], v[112:115], v[108:111]
  ds_write_b64 v13, v[92:93] offset:12288
  ds_read_b128 v[140:143], v4 offset:48128
  s_waitcnt lgkmcnt(8)
  v_mfma_f32_16x16x32_bf16 v[100:103], a[60:63], v[116:119], v[100:103]
  v_cvt_pk_bf16_f32 v96, v96, v97
  v_mfma_f32_16x16x32_bf16 v[104:107], a[64:67], v[116:119], v[104:107]
  v_cvt_pk_bf16_f32 v97, v98, v99
  v_mfma_f32_16x16x32_bf16 v[108:111], a[68:71], v[116:119], v[108:111]
  ds_write_b64 v14, v[96:97] offset:12288
  s_waitcnt lgkmcnt(8)
  v_mfma_f32_16x16x32_bf16 v[100:103], a[72:75], v[120:123], v[100:103]
  v_mfma_f32_16x16x32_bf16 v[104:107], a[76:79], v[120:123], v[104:107]
  v_mfma_f32_16x16x32_bf16 v[108:111], a[80:83], v[120:123], v[108:111]
  s_waitcnt lgkmcnt(7)
  v_mfma_f32_16x16x32_bf16 v[100:103], a[84:87], v[124:127], v[100:103]
  v_mfma_f32_16x16x32_bf16 v[104:107], a[88:91], v[124:127], v[104:107]
  v_mfma_f32_16x16x32_bf16 v[108:111], a[92:95], v[124:127], v[108:111]
  s_waitcnt lgkmcnt(6)
  v_mfma_f32_16x16x32_bf16 v[100:103], a[96:99], v[128:131], v[100:103]
  v_mfma_f32_16x16x32_bf16 v[104:107], a[100:103], v[128:131], v[104:107]
  v_mfma_f32_16x16x32_bf16 v[108:111], a[104:107], v[128:131], v[108:111]
  s_waitcnt lgkmcnt(5)
  v_mfma_f32_16x16x32_bf16 v[100:103], a[108:111], v[132:135], v[100:103]
  v_mfma_f32_16x16x32_bf16 v[104:107], a[112:115], v[132:135], v[104:107]
  v_mfma_f32_16x16x32_bf16 v[108:111], a[116:119], v[132:135], v[108:111]
  s_waitcnt lgkmcnt(3)
  v_mfma_f32_16x16x32_bf16 v[100:103], a[120:123], v[136:139], v[100:103]
  v_mfma_f32_16x16x32_bf16 v[104:107], a[124:127], v[136:139], v[104:107]
  v_mfma_f32_16x16x32_bf16 v[108:111], a[128:131], v[136:139], v[108:111]
  s_waitcnt lgkmcnt(1)
  v_mfma_f32_16x16x32_bf16 v[100:103], a[132:135], v[140:143], v[100:103]
  v_mfma_f32_16x16x32_bf16 v[104:107], a[136:139], v[140:143], v[104:107]
  v_mfma_f32_16x16x32_bf16 v[108:111], a[140:143], v[140:143], v[108:111]
  s_nop 7
  v_cvt_pk_bf16_f32 v100, v100, v101
  v_cvt_pk_bf16_f32 v101, v102, v103
  ds_write_b64 v12, v[100:101] offset:18432
  v_cvt_pk_bf16_f32 v104, v104, v105
  v_cvt_pk_bf16_f32 v105, v106, v107
  ds_write_b64 v13, v[104:105] offset:18432
  v_cvt_pk_bf16_f32 v108, v108, v109
  v_cvt_pk_bf16_f32 v109, v110, v111
  ds_write_b64 v14, v[108:109] offset:18432
  s_mul_i32 s52, s3, 6144
  s_add_u32 s52, s52, s29
  s_add_u32 s53, s52, 4096
  s_waitcnt lgkmcnt(0)
  s_barrier
  ds_read_b128 v[112:115], v15 offset:0
  ds_read_b128 v[116:119], v15 offset:1024
  ds_read_b128 v[120:123], v15 offset:2048
  ds_read_b128 v[124:127], v15 offset:3072
  ds_read_b128 v[128:131], v15 offset:4096
  ds_read_b128 v[132:135], v15 offset:5120
  s_waitcnt lgkmcnt(5)
  buffer_store_dwordx4 v[112:115], v4, s[12:15], s52 offen offset:0 sc1
  s_waitcnt lgkmcnt(4)
  buffer_store_dwordx4 v[116:119], v4, s[12:15], s52 offen offset:1024 sc1
  s_waitcnt lgkmcnt(3)
  buffer_store_dwordx4 v[120:123], v4, s[12:15], s52 offen offset:2048 sc1
  s_waitcnt lgkmcnt(2)
  buffer_store_dwordx4 v[124:127], v4, s[12:15], s52 offen offset:3072 sc1
  s_waitcnt lgkmcnt(1)
  buffer_store_dwordx4 v[128:131], v4, s[12:15], s53 offen offset:0 sc1
  s_waitcnt lgkmcnt(0)
  buffer_store_dwordx4 v[132:135], v4, s[12:15], s53 offen offset:1024 sc1
  s_branch mega_kernel_qdone
mega_kernel_v:
  ds_read_b128 v[112:115], v4 offset:0
  ds_read_b128 v[116:119], v4 offset:1024
  ds_read_b128 v[120:123], v4 offset:2048
  ds_read_b128 v[124:127], v4 offset:3072
  ds_read_b128 v[128:131], v4 offset:4096
  ds_read_b128 v[132:135], v4 offset:5120
  ds_read_b128 v[136:139], v4 offset:6144
  s_waitcnt lgkmcnt(6)
  v_mfma_f32_16x16x32_bf16 v[64:67], v[112:115], a[0:3], 0
  v_mfma_f32_16x16x32_bf16 v[68:71], v[112:115], a[4:7], 0
  v_mfma_f32_16x16x32_bf16 v[72:75], v[112:115], a[8:11], 0
  ds_read_b128 v[140:143], v4 offset:7168
  s_waitcnt lgkmcnt(6)
  v_mfma_f32_16x16x32_bf16 v[64:67], v[116:119], a[12:15], v[64:67]
  v_mfma_f32_16x16x32_bf16 v[68:71], v[116:119], a[16:19], v[68:71]
  v_mfma_f32_16x16x32_bf16 v[72:75], v[116:119], a[20:23], v[72:75]
  ds_read_b128 v[112:115], v4 offset:8192
  s_waitcnt lgkmcnt(6)
  v_mfma_f32_16x16x32_bf16 v[64:67], v[120:123], a[24:27], v[64:67]
  v_mfma_f32_16x16x32_bf16 v[68:71], v[120:123], a[28:31], v[68:71]
  v_mfma_f32_16x16x32_bf16 v[72:75], v[120:123], a[32:35], v[72:75]
  ds_read_b128 v[116:119], v4 offset:9216
  s_waitcnt lgkmcnt(6)
  v_mfma_f32_16x16x32_bf16 v[64:67], v[124:127], a[36:39], v[64:67]
  v_mfma_f32_16x16x32_bf16 v[68:71], v[124:127], a[40:43], v[68:71]
  v_mfma_f32_16x16x32_bf16 v[72:75], v[124:127], a[44:47], v[72:75]
  ds_read_b128 v[120:123], v4 offset:10240
  s_waitcnt lgkmcnt(6)
  v_mfma_f32_16x16x32_bf16 v[64:67], v[128:131], a[48:51], v[64:67]
  v_mfma_f32_16x16x32_bf16 v[68:71], v[128:131], a[52:55], v[68:71]
  v_mfma_f32_16x16x32_bf16 v[72:75], v[128:131], a[56:59], v[72:75]
  ds_read_b128 v[124:127], v4 offset:11264
  s_waitcnt lgkmcnt(6)
  v_mfma_f32_16x16x32_bf16 v[64:67], v[132:135], a[60:63], v[64:67]
  v_mfma_f32_16x16x32_bf16 v[68:71], v[132:135], a[64:67], v[68:71]
  v_mfma_f32_16x16x32_bf16 v[72:75], v[132:135], a[68:71], v[72:75]
  ds_read_b128 v[128:131], v4 offset:12288
  s_waitcnt lgkmcnt(6)
  v_mfma_f32_16x16x32_bf16 v[64:67], v[136:139], a[72:75], v[64:67]
  v_mfma_f32_16x16x32_bf16 v[68:71], v[136:139], a[76:79], v[68:71]
  v_mfma_f32_16x16x32_bf16 v[72:75], v[136:139], a[80:83], v[72:75]
  ds_read_b128 v[132:135], v4 offset:13312
  s_waitcnt lgkmcnt(6)
  v_mfma_f32_16x16x32_bf16 v[64:67], v[140:143], a[84:87], v[64:67]
  v_mfma_f32_16x16x32_bf16 v[68:71], v[140:143], a[88:91], v[68:71]
  v_mfma_f32_16x16x32_bf16 v[72:75], v[140:143], a[92:95], v[72:75]
  ds_read_b128 v[136:139], v4 offset:14336
  s_waitcnt lgkmcnt(6)
  v_mfma_f32_16x16x32_bf16 v[64:67], v[112:115], a[96:99], v[64:67]
  v_mfma_f32_16x16x32_bf16 v[68:71], v[112:115], a[100:103], v[68:71]
  v_mfma_f32_16x16x32_bf16 v[72:75], v[112:115], a[104:107], v[72:75]
  ds_read_b128 v[140:143], v4 offset:15360
  s_waitcnt lgkmcnt(6)
  v_mfma_f32_16x16x32_bf16 v[64:67], v[116:119], a[108:111], v[64:67]
  v_mfma_f32_16x16x32_bf16 v[68:71], v[116:119], a[112:115], v[68:71]
  v_mfma_f32_16x16x32_bf16 v[72:75], v[116:119], a[116:119], v[72:75]
  ds_read_b128 v[112:115], v4 offset:16384
  s_waitcnt lgkmcnt(6)
  v_mfma_f32_16x16x32_bf16 v[64:67], v[120:123], a[120:123], v[64:67]
  v_mfma_f32_16x16x32_bf16 v[68:71], v[120:123], a[124:127], v[68:71]
  v_mfma_f32_16x16x32_bf16 v[72:75], v[120:123], a[128:131], v[72:75]
  ds_read_b128 v[116:119], v4 offset:17408
  s_waitcnt lgkmcnt(6)
  v_mfma_f32_16x16x32_bf16 v[64:67], v[124:127], a[132:135], v[64:67]
  v_mfma_f32_16x16x32_bf16 v[68:71], v[124:127], a[136:139], v[68:71]
  v_mfma_f32_16x16x32_bf16 v[72:75], v[124:127], a[140:143], v[72:75]
  ds_read_b128 v[120:123], v4 offset:18432
  s_waitcnt lgkmcnt(6)
  v_mfma_f32_16x16x32_bf16 v[76:79], v[128:131], a[0:3], 0
  v_mfma_f32_16x16x32_bf16 v[80:83], v[128:131], a[4:7], 0
  v_mfma_f32_16x16x32_bf16 v[84:87], v[128:131], a[8:11], 0
  ds_read_b128 v[124:127], v4 offset:19456
  s_waitcnt lgkmcnt(6)
  v_mfma_f32_16x16x32_bf16 v[76:79], v[132:135], a[12:15], v[76:79]
  v_mfma_f32_16x16x32_bf16 v[80:83], v[132:135], a[16:19], v[80:83]
  v_mfma_f32_16x16x32_bf16 v[84:87], v[132:135], a[20:23], v[84:87]
  ds_read_b128 v[128:131], v4 offset:20480
  s_waitcnt lgkmcnt(6)
  v_mfma_f32_16x16x32_bf16 v[76:79], v[136:139], a[24:27], v[76:79]
  v_mfma_f32_16x16x32_bf16 v[80:83], v[136:139], a[28:31], v[80:83]
  v_mfma_f32_16x16x32_bf16 v[84:87], v[136:139], a[32:35], v[84:87]
  ds_read_b128 v[132:135], v4 offset:21504
  s_waitcnt lgkmcnt(6)
  v_mfma_f32_16x16x32_bf16 v[76:79], v[140:143], a[36:39], v[76:79]
  v_mfma_f32_16x16x32_bf16 v[80:83], v[140:143], a[40:43], v[80:83]
  v_mfma_f32_16x16x32_bf16 v[84:87], v[140:143], a[44:47], v[84:87]
  ds_read_b128 v[136:139], v4 offset:22528
  s_waitcnt lgkmcnt(6)
  v_mfma_f32_16x16x32_bf16 v[76:79], v[112:115], a[48:51], v[76:79]
  v_mfma_f32_16x16x32_bf16 v[80:83], v[112:115], a[52:55], v[80:83]
  v_mfma_f32_16x16x32_bf16 v[84:87], v[112:115], a[56:59], v[84:87]
  ds_read_b128 v[140:143], v4 offset:23552
  s_waitcnt lgkmcnt(6)
  v_mfma_f32_16x16x32_bf16 v[76:79], v[116:119], a[60:63], v[76:79]
  v_mfma_f32_16x16x32_bf16 v[80:83], v[116:119], a[64:67], v[80:83]
  v_mfma_f32_16x16x32_bf16 v[84:87], v[116:119], a[68:71], v[84:87]
  ds_read_b128 v[112:115], v4 offset:24576
  s_waitcnt lgkmcnt(6)
  v_mfma_f32_16x16x32_bf16 v[76:79], v[120:123], a[72:75], v[76:79]
  v_mfma_f32_16x16x32_bf16 v[80:83], v[120:123], a[76:79], v[80:83]
  v_mfma_f32_16x16x32_bf16 v[84:87], v[120:123], a[80:83], v[84:87]
  ds_read_b128 v[116:119], v4 offset:25600
  s_waitcnt lgkmcnt(6)
  v_mfma_f32_16x16x32_bf16 v[76:79], v[124:127], a[84:87], v[76:79]
  v_mfma_f32_16x16x32_bf16 v[80:83], v[124:127], a[88:91], v[80:83]
  v_mfma_f32_16x16x32_bf16 v[84:87], v[124:127], a[92:95], v[84:87]
  ds_read_b128 v[120:123], v4 offset:26624
  s_waitcnt lgkmcnt(6)
  v_mfma_f32_16x16x32_bf16 v[76:79], v[128:131], a[96:99], v[76:79]
  v_mfma_f32_16x16x32_bf16 v[80:83], v[128:131], a[100:103], v[80:83]
  v_mfma_f32_16x16x32_bf16 v[84:87], v[128:131], a[104:107], v[84:87]
  ds_read_b128 v[124:127], v4 offset:27648
  s_waitcnt lgkmcnt(6)
  v_mfma_f32_16x16x32_bf16 v[76:79], v[132:135], a[108:111], v[76:79]
  v_mfma_f32_16x16x32_bf16 v[80:83], v[132:135], a[112:115], v[80:83]
  v_mfma_f32_16x16x32_bf16 v[84:87], v[132:135], a[116:119], v[84:87]
  ds_read_b128 v[128:131], v4 offset:28672
  s_waitcnt lgkmcnt(6)
  v_mfma_f32_16x16x32_bf16 v[76:79], v[136:139], a[120:123], v[76:79]
  v_mfma_f32_16x16x32_bf16 v[80:83], v[136:139], a[124:127], v[80:83]
  v_mfma_f32_16x16x32_bf16 v[84:87], v[136:139], a[128:131], v[84:87]
  ds_read_b128 v[132:135], v4 offset:29696
  s_waitcnt lgkmcnt(6)
  v_mfma_f32_16x16x32_bf16 v[76:79], v[140:143], a[132:135], v[76:79]
  v_mfma_f32_16x16x32_bf16 v[80:83], v[140:143], a[136:139], v[80:83]
  v_mfma_f32_16x16x32_bf16 v[84:87], v[140:143], a[140:143], v[84:87]
  ds_read_b128 v[136:139], v4 offset:30720
  s_waitcnt lgkmcnt(6)
  v_mfma_f32_16x16x32_bf16 v[88:91], v[112:115], a[0:3], 0
  v_mfma_f32_16x16x32_bf16 v[92:95], v[112:115], a[4:7], 0
  v_mfma_f32_16x16x32_bf16 v[96:99], v[112:115], a[8:11], 0
  ds_read_b128 v[140:143], v4 offset:31744
  s_waitcnt lgkmcnt(6)
  v_mfma_f32_16x16x32_bf16 v[88:91], v[116:119], a[12:15], v[88:91]
  v_mfma_f32_16x16x32_bf16 v[92:95], v[116:119], a[16:19], v[92:95]
  v_mfma_f32_16x16x32_bf16 v[96:99], v[116:119], a[20:23], v[96:99]
  ds_read_b128 v[112:115], v4 offset:32768
  s_waitcnt lgkmcnt(6)
  v_mfma_f32_16x16x32_bf16 v[88:91], v[120:123], a[24:27], v[88:91]
  v_mfma_f32_16x16x32_bf16 v[92:95], v[120:123], a[28:31], v[92:95]
  v_mfma_f32_16x16x32_bf16 v[96:99], v[120:123], a[32:35], v[96:99]
  ds_read_b128 v[116:119], v4 offset:33792
  s_waitcnt lgkmcnt(6)
  v_mfma_f32_16x16x32_bf16 v[88:91], v[124:127], a[36:39], v[88:91]
  v_mfma_f32_16x16x32_bf16 v[92:95], v[124:127], a[40:43], v[92:95]
  v_mfma_f32_16x16x32_bf16 v[96:99], v[124:127], a[44:47], v[96:99]
  ds_read_b128 v[120:123], v4 offset:34816
  s_waitcnt lgkmcnt(6)
  v_mfma_f32_16x16x32_bf16 v[88:91], v[128:131], a[48:51], v[88:91]
  v_mfma_f32_16x16x32_bf16 v[92:95], v[128:131], a[52:55], v[92:95]
  v_mfma_f32_16x16x32_bf16 v[96:99], v[128:131], a[56:59], v[96:99]
  ds_read_b128 v[124:127], v4 offset:35840
  s_waitcnt lgkmcnt(6)
  v_mfma_f32_16x16x32_bf16 v[88:91], v[132:135], a[60:63], v[88:91]
  v_mfma_f32_16x16x32_bf16 v[92:95], v[132:135], a[64:67], v[92:95]
  v_mfma_f32_16x16x32_bf16 v[96:99], v[132:135], a[68:71], v[96:99]
  ds_read_b128 v[128:131], v4 offset:36864
  s_waitcnt lgkmcnt(6)
  v_mfma_f32_16x16x32_bf16 v[88:91], v[136:139], a[72:75], v[88:91]
  v_mfma_f32_16x16x32_bf16 v[92:95], v[136:139], a[76:79], v[92:95]
  v_mfma_f32_16x16x32_bf16 v[96:99], v[136:139], a[80:83], v[96:99]
  ds_read_b128 v[132:135], v4 offset:37888
  s_waitcnt lgkmcnt(6)
  v_mfma_f32_16x16x32_bf16 v[88:91], v[140:143], a[84:87], v[88:91]
  v_mfma_f32_16x16x32_bf16 v[92:95], v[140:143], a[88:91], v[92:95]
  v_mfma_f32_16x16x32_bf16 v[96:99], v[140:143], a[92:95], v[96:99]
  ds_read_b128 v[136:139], v4 offset:38912
  s_waitcnt lgkmcnt(6)
  v_mfma_f32_16x16x32_bf16 v[88:91], v[112:115], a[96:99], v[88:91]
  v_mfma_f32_16x16x32_bf16 v[92:95], v[112:115], a[100:103], v[92:95]
  v_mfma_f32_16x16x32_bf16 v[96:99], v[112:115], a[104:107], v[96:99]
  ds_read_b128 v[140:143], v4 offset:39936
  s_waitcnt lgkmcnt(6)
  v_mfma_f32_16x16x32_bf16 v[88:91], v[116:119], a[108:111], v[88:91]
  v_mfma_f32_16x16x32_bf16 v[92:95], v[116:119], a[112:115], v[92:95]
  v_mfma_f32_16x16x32_bf16 v[96:99], v[116:119], a[116:119], v[96:99]
  ds_read_b128 v[112:115], v4 offset:40960
  s_waitcnt lgkmcnt(6)
  v_mfma_f32_16x16x32_bf16 v[88:91], v[120:123], a[120:123], v[88:91]
  v_mfma_f32_16x16x32_bf16 v[92:95], v[120:123], a[124:127], v[92:95]
  v_mfma_f32_16x16x32_bf16 v[96:99], v[120:123], a[128:131], v[96:99]
  ds_read_b128 v[116:119], v4 offset:41984
  s_waitcnt lgkmcnt(6)
  v_mfma_f32_16x16x32_bf16 v[88:91], v[124:127], a[132:135], v[88:91]
  v_mfma_f32_16x16x32_bf16 v[92:95], v[124:127], a[136:139], v[92:95]
  v_mfma_f32_16x16x32_bf16 v[96:99], v[124:127], a[140:143], v[96:99]
  ds_read_b128 v[120:123], v4 offset:43008
  s_waitcnt lgkmcnt(6)
  v_mfma_f32_16x16x32_bf16 v[100:103], v[128:131], a[0:3], 0
  v_mfma_f32_16x16x32_bf16 v[104:107], v[128:131], a[4:7], 0
  v_mfma_f32_16x16x32_bf16 v[108:111], v[128:131], a[8:11], 0
  ds_read_b128 v[124:127], v4 offset:44032
  s_waitcnt lgkmcnt(6)
  v_mfma_f32_16x16x32_bf16 v[100:103], v[132:135], a[12:15], v[100:103]
  v_mfma_f32_16x16x32_bf16 v[104:107], v[132:135], a[16:19], v[104:107]
  v_mfma_f32_16x16x32_bf16 v[108:111], v[132:135], a[20:23], v[108:111]
  ds_read_b128 v[128:131], v4 offset:45056
  s_waitcnt lgkmcnt(6)
  v_mfma_f32_16x16x32_bf16 v[100:103], v[136:139], a[24:27], v[100:103]
  v_mfma_f32_16x16x32_bf16 v[104:107], v[136:139], a[28:31], v[104:107]
  v_mfma_f32_16x16x32_bf16 v[108:111], v[136:139], a[32:35], v[108:111]
  ds_read_b128 v[132:135], v4 offset:46080
  s_waitcnt lgkmcnt(6)
  v_mfma_f32_16x16x32_bf16 v[100:103], v[140:143], a[36:39], v[100:103]
  v_mfma_f32_16x16x32_bf16 v[104:107], v[140:143], a[40:43], v[104:107]
  v_mfma_f32_16x16x32_bf16 v[108:111], v[140:143], a[44:47], v[108:111]
  ds_read_b128 v[136:139], v4 offset:47104
  s_waitcnt lgkmcnt(6)
  v_mfma_f32_16x16x32_bf16 v[100:103], v[112:115], a[48:51], v[100:103]
  v_mfma_f32_16x16x32_bf16 v[104:107], v[112:115], a[52:55], v[104:107]
  v_mfma_f32_16x16x32_bf16 v[108:111], v[112:115], a[56:59], v[108:111]
  ds_read_b128 v[140:143], v4 offset:48128
  s_waitcnt lgkmcnt(6)
  v_mfma_f32_16x16x32_bf16 v[100:103], v[116:119], a[60:63], v[100:103]
  v_mfma_f32_16x16x32_bf16 v[104:107], v[116:119], a[64:67], v[104:107]
  v_mfma_f32_16x16x32_bf16 v[108:111], v[116:119], a[68:71], v[108:111]
  s_waitcnt lgkmcnt(5)
  v_mfma_f32_16x16x32_bf16 v[100:103], v[120:123], a[72:75], v[100:103]
  v_mfma_f32_16x16x32_bf16 v[104:107], v[120:123], a[76:79], v[104:107]
  v_mfma_f32_16x16x32_bf16 v[108:111], v[120:123], a[80:83], v[108:111]
  s_waitcnt lgkmcnt(4)
  v_mfma_f32_16x16x32_bf16 v[100:103], v[124:127], a[84:87], v[100:103]
  v_mfma_f32_16x16x32_bf16 v[104:107], v[124:127], a[88:91], v[104:107]
  v_mfma_f32_16x16x32_bf16 v[108:111], v[124:127], a[92:95], v[108:111]
  s_waitcnt lgkmcnt(3)
  v_mfma_f32_16x16x32_bf16 v[100:103], v[128:131], a[96:99], v[100:103]
  v_mfma_f32_16x16x32_bf16 v[104:107], v[128:131], a[100:103], v[104:107]
  v_mfma_f32_16x16x32_bf16 v[108:111], v[128:131], a[104:107], v[108:111]
  s_waitcnt lgkmcnt(2)
  v_mfma_f32_16x16x32_bf16 v[100:103], v[132:135], a[108:111], v[100:103]
  v_mfma_f32_16x16x32_bf16 v[104:107], v[132:135], a[112:115], v[104:107]
  v_mfma_f32_16x16x32_bf16 v[108:111], v[132:135], a[116:119], v[108:111]
  s_waitcnt lgkmcnt(1)
  v_mfma_f32_16x16x32_bf16 v[100:103], v[136:139], a[120:123], v[100:103]
  v_mfma_f32_16x16x32_bf16 v[104:107], v[136:139], a[124:127], v[104:107]
  v_mfma_f32_16x16x32_bf16 v[108:111], v[136:139], a[128:131], v[108:111]
  s_waitcnt lgkmcnt(0)
  v_mfma_f32_16x16x32_bf16 v[100:103], v[140:143], a[132:135], v[100:103]
  v_mfma_f32_16x16x32_bf16 v[104:107], v[140:143], a[136:139], v[104:107]
  v_mfma_f32_16x16x32_bf16 v[108:111], v[140:143], a[140:143], v[108:111]
  s_nop 7
  s_nop 0
  s_mul_i32 s56, s3, 3072
  s_add_u32 s56, s56, s29
  s_add_u32 s57, s56, 12288
  s_nop 4
  v_cvt_pk_bf16_f32 v64, v64, v65
  v_cvt_pk_bf16_f32 v65, v66, v67
  v_cvt_pk_bf16_f32 v66, v76, v77
  v_cvt_pk_bf16_f32 v67, v78, v79
  buffer_store_dwordx4 v[64:67], v4, s[12:15], s56 offen offset:0 sc1
  v_cvt_pk_bf16_f32 v68, v68, v69
  v_cvt_pk_bf16_f32 v69, v70, v71
  v_cvt_pk_bf16_f32 v70, v80, v81
  v_cvt_pk_bf16_f32 v71, v82, v83
  buffer_store_dwordx4 v[68:71], v4, s[12:15], s56 offen offset:1024 sc1
  v_cvt_pk_bf16_f32 v72, v72, v73
  v_cvt_pk_bf16_f32 v73, v74, v75
  v_cvt_pk_bf16_f32 v74, v84, v85
  v_cvt_pk_bf16_f32 v75, v86, v87
  buffer_store_dwordx4 v[72:75], v4, s[12:15], s56 offen offset:2048 sc1
  v_cvt_pk_bf16_f32 v88, v88, v89
  v_cvt_pk_bf16_f32 v89, v90, v91
  v_cvt_pk_bf16_f32 v90, v100, v101
  v_cvt_pk_bf16_f32 v91, v102, v103
  buffer_store_dwordx4 v[88:91], v4, s[12:15], s57 offen offset:0 sc1
  v_cvt_pk_bf16_f32 v92, v92, v93
  v_cvt_pk_bf16_f32 v93, v94, v95
  v_cvt_pk_bf16_f32 v94, v104, v105
  v_cvt_pk_bf16_f32 v95, v106, v107
  buffer_store_dwordx4 v[92:95], v4, s[12:15], s57 offen offset:1024 sc1
  v_cvt_pk_bf16_f32 v96, v96, v97
  v_cvt_pk_bf16_f32 v97, v98, v99
  v_cvt_pk_bf16_f32 v98, v108, v109
  v_cvt_pk_bf16_f32 v99, v110, v111
  buffer_store_dwordx4 v[96:99], v4, s[12:15], s57 offen offset:2048 sc1
mega_kernel_qdone:
  s_lshl_b32 s56, s20, 10
  s_lshl_b32 s57, s21, 7
  s_add_u32 s56, s56, s57
  s_add_u32 s56, s56, 2752512
  v_mov_b32 v10, 0
  v_mov_b32 v11, 1
  s_cmp_lg_u32 s3, 0
  s_waitcnt vmcnt(0)
  s_barrier
  s_cbranch_scc1 mega_kernel_pubq
  s_mov_b64 exec, 1
  buffer_store_dword v11, v10, s[12:15], s56 offen sc1
  s_mov_b64 exec, -1
mega_kernel_pubq:
mega_kernel_attn:
  s_cmp_lg_u32 s3, 0
  s_cbranch_scc1 mega_kernel_r1
  v_readfirstlane_b32 s26, v5
  s_mov_b32 s25, s33
  s_mov_b32 s27, 1
  s_cmp_lt_u32 s26, 32
  s_cbranch_scc1 mega_kernel_r0
  v_and_b32 v10, 7, v1
  v_lshlrev_b32 v10, 2, v10
  s_mov_b32 s57, 0x100000
mega_kernel_rl:
  buffer_load_dword v11, v10, s[96:99], 0 offen sc1
  s_waitcnt vmcnt(0)
  s_mov_b32 s28, 0
  v_readlane_b32 s40, v11, 0
  s_nop 0
  s_add_u32 s28, s28, s40
  v_readlane_b32 s41, v11, 1
  s_nop 0
  s_add_u32 s28, s28, s41
  v_readlane_b32 s42, v11, 2
  s_nop 0
  s_add_u32 s28, s28, s42
  v_readlane_b32 s43, v11, 3
  s_nop 0
  s_add_u32 s28, s28, s43
  v_readlane_b32 s44, v11, 4
  s_nop 0
  s_add_u32 s28, s28, s44
  v_readlane_b32 s45, v11, 5
  s_nop 0
  s_add_u32 s28, s28, s45
  v_readlane_b32 s46, v11, 6
  s_nop 0
  s_add_u32 s28, s28, s46
  v_readlane_b32 s47, v11, 7
  s_nop 0
  s_add_u32 s28, s28, s47
  s_sub_u32 s57, s57, 1
  s_cbranch_scc1 mega_kernel_rg
  s_cmp_lt_u32 s28, 256
  s_cbranch_scc1 mega_kernel_rl
mega_kernel_rg:
  s_sub_u32 s26, s26, 32
  s_max_u32 s28, s40, 32
  s_sub_u32 s28, s28, 32
  s_cmp_lt_u32 0, s33
  s_cselect_b32 s28, s28, 0
  s_add_u32 s26, s26, s28
  s_max_u32 s28, s41, 32
  s_sub_u32 s28, s28, 32
  s_cmp_lt_u32 1, s33
  s_cselect_b32 s28, s28, 0
  s_add_u32 s26, s26, s28
  s_max_u32 s28, s42, 32
  s_sub_u32 s28, s28, 32
  s_cmp_lt_u32 2, s33
  s_cselect_b32 s28, s28, 0
  s_add_u32 s26, s26, s28
  s_max_u32 s28, s43, 32
  s_sub_u32 s28, s28, 32
  s_cmp_lt_u32 3, s33
  s_cselect_b32 s28, s28, 0
  s_add_u32 s26, s26, s28
  s_max_u32 s28, s44, 32
  s_sub_u32 s28, s28, 32
  s_cmp_lt_u32 4, s33
  s_cselect_b32 s28, s28, 0
  s_add_u32 s26, s26, s28
  s_max_u32 s28, s45, 32
  s_sub_u32 s28, s28, 32
  s_cmp_lt_u32 5, s33
  s_cselect_b32 s28, s28, 0
  s_add_u32 s26, s26, s28
  s_max_u32 s28, s46, 32
  s_sub_u32 s28, s28, 32
  s_cmp_lt_u32 6, s33
  s_cselect_b32 s28, s28, 0
  s_add_u32 s26, s26, s28
  s_max_u32 s28, s47, 32
  s_sub_u32 s28, s28, 32
  s_cmp_lt_u32 7, s33
  s_cselect_b32 s28, s28, 0
  s_add_u32 s26, s26, s28
  s_mov_b32 s27, 0
  s_min_u32 s28, s40, 32
  s_sub_u32 s29, 32, s28
  s_mov_b32 s25, 0
  s_cmp_lt_u32 s26, s29
  s_cselect_b32 s28, s28, 0
  s_cbranch_scc1 mega_kernel_rf
  s_sub_u32 s26, s26, s29
  s_min_u32 s28, s41, 32
  s_sub_u32 s29, 32, s28
  s_mov_b32 s25, 1
  s_cmp_lt_u32 s26, s29
  s_cselect_b32 s28, s28, 0
  s_cbranch_scc1 mega_kernel_rf
  s_sub_u32 s26, s26, s29
  s_min_u32 s28, s42, 32
  s_sub_u32 s29, 32, s28
  s_mov_b32 s25, 2
  s_cmp_lt_u32 s26, s29
  s_cselect_b32 s28, s28, 0
  s_cbranch_scc1 mega_kernel_rf
  s_sub_u32 s26, s26, s29
  s_min_u32 s28, s43, 32
  s_sub_u32 s29, 32, s28
  s_mov_b32 s25, 3
  s_cmp_lt_u32 s26, s29
  s_cselect_b32 s28, s28, 0
  s_cbranch_scc1 mega_kernel_rf
  s_sub_u32 s26, s26, s29
  s_min_u32 s28, s44, 32
  s_sub_u32 s29, 32, s28
  s_mov_b32 s25, 4
  s_cmp_lt_u32 s26, s29
  s_cselect_b32 s28, s28, 0
  s_cbranch_scc1 mega_kernel_rf
  s_sub_u32 s26, s26, s29
  s_min_u32 s28, s45, 32
  s_sub_u32 s29, 32, s28
  s_mov_b32 s25, 5
  s_cmp_lt_u32 s26, s29
  s_cselect_b32 s28, s28, 0
  s_cbranch_scc1 mega_kernel_rf
  s_sub_u32 s26, s26, s29
  s_min_u32 s28, s46, 32
  s_sub_u32 s29, 32, s28
  s_mov_b32 s25, 6
  s_cmp_lt_u32 s26, s29
  s_cselect_b32 s28, s28, 0
  s_cbranch_scc1 mega_kernel_rf
  s_sub_u32 s26, s26, s29
  s_min_u32 s28, s47, 32
  s_sub_u32 s29, 32, s28
  s_mov_b32 s25, 7
  s_cmp_lt_u32 s26, s29
  s_cselect_b32 s28, s28, 0
  s_cbranch_scc1 mega_kernel_rf
  s_sub_u32 s26, s26, s29
mega_kernel_rf:
  s_add_u32 s26, s26, s28
  s_and_b32 s26, s26, 31
mega_kernel_r0:
  v_mov_b32 v10, s25
  v_mov_b32 v11, s26
  v_mov_b32 v12, s27
  v_mov_b32 v13, 90112
  ds_write_b96 v13, v[10:12]
  s_waitcnt lgkmcnt(0)
mega_kernel_r1:
  s_barrier
  v_mov_b32 v13, 90112
  ds_read_b96 v[10:12], v13
  s_waitcnt lgkmcnt(0)
  v_readfirstlane_b32 s25, v10
  v_readfirstlane_b32 s26, v11
  v_readfirstlane_b32 s63, v12
  s_and_b32 s27, s26, 3
  s_lshl_b32 s20, s25, 2
  s_add_u32 s20, s20, s27
  s_lshr_b32 s21, s26, 2
  s_lshr_b32 s22, s20, 4
  s_lshl_b32 s22, s22, 1
  s_lshr_b32 s27, s21, 2
  s_add_u32 s22, s22, s27
  s_and_b32 s23, s21, 3
  s_and_b32 s24, s20, 15
  s_and_b32 s27, s21, 1
  s_lshl_b32 s36, s20, 1
  s_add_u32 s36, s36, s27
  s_lshr_b32 s37, s21, 1
  s_lshl_b32 s28, s21, 2
  s_add_u32 s28, s28, s3
  s_mul_i32 s28, s28, 36864
  s_add_u32 s38, s28, 360448
  s_mul_i32 s39, s21, 147456
  s_mul_i32 s29, s3, 12288
  s_add_u32 s39, s39, s29
  s_add_u32 s39, s39, 1540096
  s_mul_i32 s35, s37, 73728
  s_mul_i32 s29, s3, 3072
  s_add_u32 s35, s35, s29
  s_add_u32 s35, s35, 65536
  s_lshl_b32 s25, s22, 6
  s_lshl_b32 s26, s24, 2
  s_add_u32 s26, s26, s25
  s_add_u32 s26, s26, s3
  s_mul_i32 s26, s26, 6144
  s_add_u32 s26, s26, 4456448
  s_lshl_b32 s29, s23, 4
  s_add_u32 s29, s29, s25
  s_lshl_b32 s27, s3, 2
  s_add_u32 s29, s29, s27
  s_mul_i32 s29, s29, 6144
  s_add_u32 s29, s29, 6029312
  s_lshl_b32 s34, s22, 5
  s_lshl_b32 s27, s23, 3
  s_add_u32 s34, s34, s27
  s_mul_i32 s34, s34, 12288
  s_mul_i32 s27, s3, 3072
  s_add_u32 s34, s34, s27
  s_add_u32 s34, s34, 7602176
  s_lshr_b32 s40, s22, 1
  s_lshl_b32 s40, s40, 4
  s_and_b32 s41, s22, 1
  s_lshl_b32 s42, s23, 2
  s_add_u32 s42, s42, s40
  s_add_u32 s43, s40, s24
  v_and_b32 v10, 3, v1
  v_mov_b32 v11, s3
  v_cmp_gt_u32 vcc, 4, v1
  s_nop 1
  v_cndmask_b32 v10, v10, v11, vcc
  v_add_u32 v10, s42, v10
  v_lshlrev_b32 v10, 7, v10
  v_lshrrev_b32 v11, 2, v1
  v_lshl_add_u32 v10, v11, 3, v10
  s_lshl_b32 s44, s41, 2
  s_add_u32 s45, s44, 8
  v_add_u32 v10, s45, v10
  s_lshl_b32 s45, s43, 7
  s_add_u32 s45, s45, s44
  v_mov_b32 v11, s45
  v_cmp_gt_u32 vcc, 8, v1
  s_nop 1
  v_cndmask_b32 v10, v11, v10, vcc
  s_mul_i32 s27, s3, 6144
  s_mov_b32 m0, s27
  s_add_u32 s28, s26, 4096
  v_and_b32 v11, 31, v10
  v_lshrrev_b32 v10, 7, v10
  v_lshlrev_b32 v10, 10, v10
  v_lshl_add_u32 v10, v11, 5, v10
  s_mov_b32 s56, 2752512
  s_mov_b32 s57, 0x100000
mega_kernel_pla:
  buffer_load_dword v11, v10, s[12:15], s56 offen sc1
  s_waitcnt vmcnt(0)
  v_cmp_ne_u32 vcc, 1, v11
  s_sub_u32 s57, s57, 1
  s_cbranch_scc1 mega_kernel_pda
  s_cbranch_vccz mega_kernel_pda
  s_sleep 5
  s_branch mega_kernel_pla
mega_kernel_pda:
  buffer_load_dwordx4 v4, s[12:15], s26 offen offset:0 sc1 lds
  buffer_load_dwordx4 v4, s[12:15], s26 offen offset:1024 sc1 lds
  buffer_load_dwordx4 v4, s[12:15], s26 offen offset:2048 sc1 lds
  buffer_load_dwordx4 v4, s[12:15], s26 offen offset:3072 sc1 lds
  s_add_u32 s27, s27, 4096
  s_mov_b32 m0, s27
  s_nop 0
  buffer_load_dwordx4 v4, s[12:15], s28 offen offset:0 sc1 lds
  buffer_load_dwordx4 v4, s[12:15], s28 offen offset:1024 sc1 lds
  v_mov_b32 v9, 132
  buffer_load_dwordx2 v[6:7], v9, s[96:99], 0 offen sc1
  s_add_u32 s64, s29, 0
  buffer_load_dwordx4 a[0:3], v4, s[12:15], s64 offen offset:0 sc1
  buffer_load_dwordx4 a[16:19], v4, s[12:15], s64 offen offset:1024 sc1
  s_add_u32 s65, s29, 4096
  buffer_load_dwordx4 a[4:7], v4, s[12:15], s65 offen offset:2048 sc1
  buffer_load_dwordx4 a[20:23], v4, s[12:15], s65 offen offset:3072 sc1
  s_add_u32 s66, s29, 12288
  buffer_load_dwordx4 a[8:11], v4, s[12:15], s66 offen offset:0 sc1
  buffer_load_dwordx4 a[24:27], v4, s[12:15], s66 offen offset:1024 sc1
  s_add_u32 s67, s29, 16384
  buffer_load_dwordx4 a[12:15], v4, s[12:15], s67 offen offset:2048 sc1
  buffer_load_dwordx4 a[28:31], v4, s[12:15], s67 offen offset:3072 sc1
  buffer_load_dwordx4 a[32:35], v4, s[12:15], s64 offen offset:2048 sc1
  buffer_load_dwordx4 a[48:51], v4, s[12:15], s64 offen offset:3072 sc1
  s_add_u32 s68, s29, 8192
  buffer_load_dwordx4 a[36:39], v4, s[12:15], s68 offen offset:0 sc1
  buffer_load_dwordx4 a[52:55], v4, s[12:15], s68 offen offset:1024 sc1
  buffer_load_dwordx4 a[40:43], v4, s[12:15], s66 offen offset:2048 sc1
  buffer_load_dwordx4 a[56:59], v4, s[12:15], s66 offen offset:3072 sc1
  s_add_u32 s69, s29, 20480
  buffer_load_dwordx4 a[44:47], v4, s[12:15], s69 offen offset:0 sc1
  buffer_load_dwordx4 a[60:63], v4, s[12:15], s69 offen offset:1024 sc1
  buffer_load_dwordx4 a[64:67], v4, s[12:15], s65 offen offset:0 sc1
  buffer_load_dwordx4 a[80:83], v4, s[12:15], s65 offen offset:1024 sc1
  buffer_load_dwordx4 a[68:71], v4, s[12:15], s68 offen offset:2048 sc1
  buffer_load_dwordx4 a[84:87], v4, s[12:15], s68 offen offset:3072 sc1
  buffer_load_dwordx4 a[72:75], v4, s[12:15], s67 offen offset:0 sc1
  buffer_load_dwordx4 a[88:91], v4, s[12:15], s67 offen offset:1024 sc1
  buffer_load_dwordx4 a[76:79], v4, s[12:15], s69 offen offset:2048 sc1
  buffer_load_dwordx4 a[92:95], v4, s[12:15], s69 offen offset:3072 sc1
  s_waitcnt vmcnt(25)
  s_barrier
  ds_read_b128 v[128:131], v4 offset:0
  ds_read_b128 v[132:135], v4 offset:6144
  ds_read_b128 v[136:139], v4 offset:12288
  ds_read_b128 v[140:143], v4 offset:18432
  ds_read_b128 v[144:147], v4 offset:1024
  ds_read_b128 v[148:151], v4 offset:7168
  ds_read_b128 v[152:155], v4 offset:13312
  ds_read_b128 v[156:159], v4 offset:19456
  s_waitcnt vmcnt(17)
  s_waitcnt lgkmcnt(7)
  v_mfma_f32_16x16x32_bf16 v[16:19], a[0:3], v[128:131], 0
  v_mfma_f32_16x16x32_bf16 v[20:23], a[4:7], v[128:131], 0
  v_mfma_f32_16x16x32_bf16 v[24:27], a[8:11], v[128:131], 0
  v_mfma_f32_16x16x32_bf16 v[28:31], a[12:15], v[128:131], 0
  s_add_u32 s70, s34, 0
  buffer_load_dwordx4 a[96:99], v4, s[12:15], s70 offen offset:0 sc1
  s_waitcnt lgkmcnt(6)
  v_mfma_f32_16x16x32_bf16 v[32:35], a[0:3], v[132:135], 0
  v_mfma_f32_16x16x32_bf16 v[36:39], a[4:7], v[132:135], 0
  v_mfma_f32_16x16x32_bf16 v[40:43], a[8:11], v[132:135], 0
  v_mfma_f32_16x16x32_bf16 v[44:47], a[12:15], v[132:135], 0
  buffer_load_dwordx4 a[100:103], v4, s[12:15], s70 offen offset:1024 sc1
  s_waitcnt lgkmcnt(5)
  v_mfma_f32_16x16x32_bf16 v[48:51], a[0:3], v[136:139], 0
  v_mfma_f32_16x16x32_bf16 v[52:55], a[4:7], v[136:139], 0
  v_mfma_f32_16x16x32_bf16 v[56:59], a[8:11], v[136:139], 0
  v_mfma_f32_16x16x32_bf16 v[60:63], a[12:15], v[136:139], 0
  buffer_load_dwordx4 a[104:107], v4, s[12:15], s70 offen offset:2048 sc1
  s_waitcnt lgkmcnt(4)
  v_mfma_f32_16x16x32_bf16 v[64:67], a[0:3], v[140:143], 0
  v_mfma_f32_16x16x32_bf16 v[68:71], a[4:7], v[140:143], 0
  v_mfma_f32_16x16x32_bf16 v[72:75], a[8:11], v[140:143], 0
  v_mfma_f32_16x16x32_bf16 v[76:79], a[12:15], v[140:143], 0
  s_add_u32 s71, s34, 12288
  buffer_load_dwordx4 a[108:111], v4, s[12:15], s71 offen offset:0 sc1
  ds_read_b128 v[128:131], v4 offset:2048
  ds_read_b128 v[132:135], v4 offset:8192
  ds_read_b128 v[136:139], v4 offset:14336
  ds_read_b128 v[140:143], v4 offset:20480
  s_waitcnt vmcnt(20)
  s_waitcnt lgkmcnt(7)
  v_mfma_f32_16x16x32_bf16 v[16:19], a[16:19], v[144:147], v[16:19]
  v_mfma_f32_16x16x32_bf16 v[20:23], a[20:23], v[144:147], v[20:23]
  v_mfma_f32_16x16x32_bf16 v[24:27], a[24:27], v[144:147], v[24:27]
  v_mfma_f32_16x16x32_bf16 v[28:31], a[28:31], v[144:147], v[28:31]
  buffer_load_dwordx4 a[112:115], v4, s[12:15], s71 offen offset:1024 sc1
  s_waitcnt lgkmcnt(6)
  v_mfma_f32_16x16x32_bf16 v[32:35], a[16:19], v[148:151], v[32:35]
  v_mfma_f32_16x16x32_bf16 v[36:39], a[20:23], v[148:151], v[36:39]
  v_mfma_f32_16x16x32_bf16 v[40:43], a[24:27], v[148:151], v[40:43]
  v_mfma_f32_16x16x32_bf16 v[44:47], a[28:31], v[148:151], v[44:47]
  buffer_load_dwordx4 a[116:119], v4, s[12:15], s71 offen offset:2048 sc1
  s_waitcnt lgkmcnt(5)
  v_mfma_f32_16x16x32_bf16 v[48:51], a[16:19], v[152:155], v[48:51]
  v_mfma_f32_16x16x32_bf16 v[52:55], a[20:23], v[152:155], v[52:55]
  v_mfma_f32_16x16x32_bf16 v[56:59], a[24:27], v[152:155], v[56:59]
  v_mfma_f32_16x16x32_bf16 v[60:63], a[28:31], v[152:155], v[60:63]
  s_add_u32 s72, s34, 24576
  buffer_load_dwordx4 a[120:123], v4, s[12:15], s72 offen offset:0 sc1
  s_waitcnt lgkmcnt(4)
  v_mfma_f32_16x16x32_bf16 v[64:67], a[16:19], v[156:159], v[64:67]
  v_mfma_f32_16x16x32_bf16 v[68:71], a[20:23], v[156:159], v[68:71]
  v_mfma_f32_16x16x32_bf16 v[72:75], a[24:27], v[156:159], v[72:75]
  v_mfma_f32_16x16x32_bf16 v[76:79], a[28:31], v[156:159], v[76:79]
  buffer_load_dwordx4 a[124:127], v4, s[12:15], s72 offen offset:1024 sc1
  ds_read_b128 v[144:147], v4 offset:3072
  ds_read_b128 v[148:151], v4 offset:9216
  ds_read_b128 v[152:155], v4 offset:15360
  ds_read_b128 v[156:159], v4 offset:21504
  s_waitcnt vmcnt(17)
  s_waitcnt lgkmcnt(7)
  v_mfma_f32_16x16x32_bf16 v[16:19], a[32:35], v[128:131], v[16:19]
  v_mfma_f32_16x16x32_bf16 v[20:23], a[36:39], v[128:131], v[20:23]
  v_mfma_f32_16x16x32_bf16 v[24:27], a[40:43], v[128:131], v[24:27]
  v_mfma_f32_16x16x32_bf16 v[28:31], a[44:47], v[128:131], v[28:31]
  buffer_load_dwordx4 a[128:131], v4, s[12:15], s72 offen offset:2048 sc1
  s_waitcnt lgkmcnt(6)
  v_mfma_f32_16x16x32_bf16 v[32:35], a[32:35], v[132:135], v[32:35]
  v_mfma_f32_16x16x32_bf16 v[36:39], a[36:39], v[132:135], v[36:39]
  v_mfma_f32_16x16x32_bf16 v[40:43], a[40:43], v[132:135], v[40:43]
  v_mfma_f32_16x16x32_bf16 v[44:47], a[44:47], v[132:135], v[44:47]
  s_add_u32 s73, s34, 36864
  buffer_load_dwordx4 a[132:135], v4, s[12:15], s73 offen offset:0 sc1
  s_waitcnt lgkmcnt(5)
  v_mfma_f32_16x16x32_bf16 v[48:51], a[32:35], v[136:139], v[48:51]
  v_mfma_f32_16x16x32_bf16 v[52:55], a[36:39], v[136:139], v[52:55]
  v_mfma_f32_16x16x32_bf16 v[56:59], a[40:43], v[136:139], v[56:59]
  v_mfma_f32_16x16x32_bf16 v[60:63], a[44:47], v[136:139], v[60:63]
  buffer_load_dwordx4 a[136:139], v4, s[12:15], s73 offen offset:1024 sc1
  s_waitcnt lgkmcnt(4)
  v_mfma_f32_16x16x32_bf16 v[64:67], a[32:35], v[140:143], v[64:67]
  v_mfma_f32_16x16x32_bf16 v[68:71], a[36:39], v[140:143], v[68:71]
  v_mfma_f32_16x16x32_bf16 v[72:75], a[40:43], v[140:143], v[72:75]
  v_mfma_f32_16x16x32_bf16 v[76:79], a[44:47], v[140:143], v[76:79]
  buffer_load_dwordx4 a[140:143], v4, s[12:15], s73 offen offset:2048 sc1
  ds_read_b128 v[128:131], v4 offset:4096
  ds_read_b128 v[132:135], v4 offset:10240
  ds_read_b128 v[136:139], v4 offset:16384
  ds_read_b128 v[140:143], v4 offset:22528
  s_waitcnt vmcnt(20)
  s_waitcnt lgkmcnt(7)
  v_mfma_f32_16x16x32_bf16 v[16:19], a[48:51], v[144:147], v[16:19]
  v_mfma_f32_16x16x32_bf16 v[20:23], a[52:55], v[144:147], v[20:23]
  v_mfma_f32_16x16x32_bf16 v[24:27], a[56:59], v[144:147], v[24:27]
  v_mfma_f32_16x16x32_bf16 v[28:31], a[60:63], v[144:147], v[28:31]
  s_add_u32 s74, s34, 49152
  buffer_load_dwordx4 a[144:147], v4, s[12:15], s74 offen offset:0 sc1
  s_waitcnt lgkmcnt(6)
  v_mfma_f32_16x16x32_bf16 v[32:35], a[48:51], v[148:151], v[32:35]
  v_mfma_f32_16x16x32_bf16 v[36:39], a[52:55], v[148:151], v[36:39]
  v_mfma_f32_16x16x32_bf16 v[40:43], a[56:59], v[148:151], v[40:43]
  v_mfma_f32_16x16x32_bf16 v[44:47], a[60:63], v[148:151], v[44:47]
  buffer_load_dwordx4 a[148:151], v4, s[12:15], s74 offen offset:1024 sc1
  s_waitcnt lgkmcnt(5)
  v_mfma_f32_16x16x32_bf16 v[48:51], a[48:51], v[152:155], v[48:51]
  v_mfma_f32_16x16x32_bf16 v[52:55], a[52:55], v[152:155], v[52:55]
  v_mfma_f32_16x16x32_bf16 v[56:59], a[56:59], v[152:155], v[56:59]
  v_mfma_f32_16x16x32_bf16 v[60:63], a[60:63], v[152:155], v[60:63]
  buffer_load_dwordx4 a[152:155], v4, s[12:15], s74 offen offset:2048 sc1
  s_waitcnt lgkmcnt(4)
  v_mfma_f32_16x16x32_bf16 v[64:67], a[48:51], v[156:159], v[64:67]
  v_mfma_f32_16x16x32_bf16 v[68:71], a[52:55], v[156:159], v[68:71]
  v_mfma_f32_16x16x32_bf16 v[72:75], a[56:59], v[156:159], v[72:75]
  v_mfma_f32_16x16x32_bf16 v[76:79], a[60:63], v[156:159], v[76:79]
  s_add_u32 s75, s34, 61440
  buffer_load_dwordx4 a[156:159], v4, s[12:15], s75 offen offset:0 sc1
  ds_read_b128 v[144:147], v4 offset:5120
  ds_read_b128 v[148:151], v4 offset:11264
  ds_read_b128 v[152:155], v4 offset:17408
  ds_read_b128 v[156:159], v4 offset:23552
  s_waitcnt vmcnt(17)
  s_waitcnt lgkmcnt(7)
  v_mfma_f32_16x16x32_bf16 v[16:19], a[64:67], v[128:131], v[16:19]
  v_mfma_f32_16x16x32_bf16 v[20:23], a[68:71], v[128:131], v[20:23]
  v_mfma_f32_16x16x32_bf16 v[24:27], a[72:75], v[128:131], v[24:27]
  v_mfma_f32_16x16x32_bf16 v[28:31], a[76:79], v[128:131], v[28:31]
  buffer_load_dwordx4 a[160:163], v4, s[12:15], s75 offen offset:1024 sc1
  s_waitcnt lgkmcnt(6)
  v_mfma_f32_16x16x32_bf16 v[32:35], a[64:67], v[132:135], v[32:35]
  v_mfma_f32_16x16x32_bf16 v[36:39], a[68:71], v[132:135], v[36:39]
  v_mfma_f32_16x16x32_bf16 v[40:43], a[72:75], v[132:135], v[40:43]
  v_mfma_f32_16x16x32_bf16 v[44:47], a[76:79], v[132:135], v[44:47]
  buffer_load_dwordx4 a[164:167], v4, s[12:15], s75 offen offset:2048 sc1
  s_waitcnt lgkmcnt(5)
  v_mfma_f32_16x16x32_bf16 v[48:51], a[64:67], v[136:139], v[48:51]
  v_mfma_f32_16x16x32_bf16 v[52:55], a[68:71], v[136:139], v[52:55]
  v_mfma_f32_16x16x32_bf16 v[56:59], a[72:75], v[136:139], v[56:59]
  v_mfma_f32_16x16x32_bf16 v[60:63], a[76:79], v[136:139], v[60:63]
  s_add_u32 s76, s34, 73728
  buffer_load_dwordx4 a[168:171], v4, s[12:15], s76 offen offset:0 sc1
  s_waitcnt lgkmcnt(4)
  v_mfma_f32_16x16x32_bf16 v[64:67], a[64:67], v[140:143], v[64:67]
  v_mfma_f32_16x16x32_bf16 v[68:71], a[68:71], v[140:143], v[68:71]
  v_mfma_f32_16x16x32_bf16 v[72:75], a[72:75], v[140:143], v[72:75]
  v_mfma_f32_16x16x32_bf16 v[76:79], a[76:79], v[140:143], v[76:79]
  buffer_load_dwordx4 a[172:175], v4, s[12:15], s76 offen offset:1024 sc1
  s_waitcnt vmcnt(20)
  s_waitcnt lgkmcnt(3)
  v_mfma_f32_16x16x32_bf16 v[16:19], a[80:83], v[144:147], v[16:19]
  v_mfma_f32_16x16x32_bf16 v[20:23], a[84:87], v[144:147], v[20:23]
  v_mfma_f32_16x16x32_bf16 v[24:27], a[88:91], v[144:147], v[24:27]
  v_mfma_f32_16x16x32_bf16 v[28:31], a[92:95], v[144:147], v[28:31]
  buffer_load_dwordx4 a[176:179], v4, s[12:15], s76 offen offset:2048 sc1
  s_waitcnt lgkmcnt(2)
  v_mfma_f32_16x16x32_bf16 v[32:35], a[80:83], v[148:151], v[32:35]
  v_mfma_f32_16x16x32_bf16 v[36:39], a[84:87], v[148:151], v[36:39]
  v_mfma_f32_16x16x32_bf16 v[40:43], a[88:91], v[148:151], v[40:43]
  v_mfma_f32_16x16x32_bf16 v[44:47], a[92:95], v[148:151], v[44:47]
  s_add_u32 s77, s34, 86016
  buffer_load_dwordx4 a[180:183], v4, s[12:15], s77 offen offset:0 sc1
  s_waitcnt lgkmcnt(1)
  v_mfma_f32_16x16x32_bf16 v[48:51], a[80:83], v[152:155], v[48:51]
  v_mfma_f32_16x16x32_bf16 v[52:55], a[84:87], v[152:155], v[52:55]
  v_mfma_f32_16x16x32_bf16 v[56:59], a[88:91], v[152:155], v[56:59]
  v_mfma_f32_16x16x32_bf16 v[60:63], a[92:95], v[152:155], v[60:63]
  buffer_load_dwordx4 a[184:187], v4, s[12:15], s77 offen offset:1024 sc1
  s_waitcnt lgkmcnt(0)
  v_mfma_f32_16x16x32_bf16 v[64:67], a[80:83], v[156:159], v[64:67]
  v_mfma_f32_16x16x32_bf16 v[68:71], a[84:87], v[156:159], v[68:71]
  v_mfma_f32_16x16x32_bf16 v[72:75], a[88:91], v[156:159], v[72:75]
  v_mfma_f32_16x16x32_bf16 v[76:79], a[92:95], v[156:159], v[76:79]
  buffer_load_dwordx4 a[188:191], v4, s[12:15], s77 offen offset:2048 sc1
  s_mov_b32 s57, 0x100000
mega_kernel_hl:
  v_readfirstlane_b32 s56, v6
  v_readfirstlane_b32 s58, v7
  s_add_u32 s56, s56, s58
  s_cmp_eq_u32 s56, 9
  s_cbranch_scc1 mega_kernel_hk
  s_sub_u32 s57, s57, 1
  s_cbranch_scc1 mega_kernel_hk
  s_sleep 2
  buffer_load_dwordx2 v[6:7], v9, s[96:99], 0 offen sc1
  s_waitcnt vmcnt(0)
  s_branch mega_kernel_hl
mega_kernel_hk:
  s_lshr_b32 s56, s20, 4
  s_mul_i32 s56, s56, 9216
  s_lshl_b32 s57, s3, 10
  s_add_u32 s56, s56, s57
  s_add_u32 s56, s56, 4608
  s_lshr_b32 s58, s20, 4
  s_mul_i32 s58, s58, 4608
  s_add_u32 s58, s58, 51456
  s_cmp_eq_u32 s3, 3
  s_cselect_b32 s56, s58, s56
  s_add_u32 m0, s57, 92160
  s_nop 0
  buffer_load_dwordx4 v4, s[12:15], s56 offen sc1 lds
  s_lshl_b32 s56, s33, 2
  v_mov_b32 v5, 0
  buffer_load_dword v5, v5, s[96:99], s56 offen sc1
  s_mov_b32 s40, 0x3dd53b95
  s_lshl_b32 s41, s3, 8
  v_lshlrev_b32 v6, 4, v2
  v_add_u32 v6, 57344, v6
  v_add_u32 v7, s41, v6
  s_mul_i32 s42, s3, 8192
  s_add_u32 s42, s42, 24576
  v_add_u32 v8, s42, v4
  s_nop 4
  v_max3_f32 v160, v16, v17, v18
  v_max3_f32 v160, v160, v19, v20
  v_max3_f32 v160, v160, v21, v22
  v_max3_f32 v160, v160, v23, v24
  v_max3_f32 v160, v160, v25, v26
  v_max3_f32 v160, v160, v27, v28
  v_max3_f32 v160, v160, v29, v30
  v_max_f32 v160, v160, v31
  v_max3_f32 v161, v32, v33, v34
  v_max3_f32 v161, v161, v35, v36
  v_max3_f32 v161, v161, v37, v38
  v_max3_f32 v161, v161, v39, v40
  v_max3_f32 v161, v161, v41, v42
  v_max3_f32 v161, v161, v43, v44
  v_max3_f32 v161, v161, v45, v46
  v_max_f32 v161, v161, v47
  v_max3_f32 v162, v48, v49, v50
  v_max3_f32 v162, v162, v51, v52
  v_max3_f32 v162, v162, v53, v54
  v_max3_f32 v162, v162, v55, v56
  v_max3_f32 v162, v162, v57, v58
  v_max3_f32 v162, v162, v59, v60
  v_max3_f32 v162, v162, v61, v62
  v_max_f32 v162, v162, v63
  v_max3_f32 v163, v64, v65, v66
  v_max3_f32 v163, v163, v67, v68
  v_max3_f32 v163, v163, v69, v70
  v_max3_f32 v163, v163, v71, v72
  v_max3_f32 v163, v163, v73, v74
  v_max3_f32 v163, v163, v75, v76
  v_max3_f32 v163, v163, v77, v78
  v_max_f32 v163, v163, v79
  v_mov_b32 v164, v160
  v_mov_b32 v165, v161
  v_mov_b32 v166, v162
  v_mov_b32 v167, v163
  s_nop 1
  v_permlane16_swap_b32 v160, v164
  v_permlane16_swap_b32 v161, v165
  v_permlane16_swap_b32 v162, v166
  v_permlane16_swap_b32 v163, v167
  s_nop 1
  v_max_f32 v160, v160, v164
  v_max_f32 v161, v161, v165
  v_max_f32 v162, v162, v166
  v_max_f32 v163, v163, v167
  v_mov_b32 v164, v160
  v_mov_b32 v165, v161
  v_mov_b32 v166, v162
  v_mov_b32 v167, v163
  s_nop 1
  v_permlane32_swap_b32 v160, v164
  v_permlane32_swap_b32 v161, v165
  v_permlane32_swap_b32 v162, v166
  v_permlane32_swap_b32 v163, v167
  s_nop 1
  v_max_f32 v160, v160, v164
  v_max_f32 v161, v161, v165
  v_max_f32 v162, v162, v166
  v_max_f32 v163, v163, v167
  ds_write_b128 v7, v[160:163]
  s_add_u32 s78, s35, 0
  buffer_load_dwordx4 a[192:195], v4, s[12:15], s78 offen offset:0 sc1
  s_waitcnt lgkmcnt(0)
  s_barrier
  ds_read_b128 v[168:171], v6 offset:0
  ds_read_b128 v[172:175], v6 offset:256
  ds_read_b128 v[176:179], v6 offset:512
  ds_read_b128 v[180:183], v6 offset:768
  buffer_load_dwordx4 a[216:219], v4, s[12:15], s78 offen offset:1024 sc1
  v_mov_b32 v164, 0x3f803f80
  v_mov_b32 v165, 0x3f803f80
  v_mov_b32 v166, 0x3f803f80
  v_mov_b32 v167, 0x3f803f80
  s_lshl_b32 s42, s3, 10
  v_add_u32 v9, s42, v4
  s_waitcnt lgkmcnt(0)
  v_max3_f32 v160, v168, v172, v176
  v_max_f32 v160, v160, v180
  v_mul_f32 v160, s40, v160
  v_ceil_f32 v160, v160
  v_max3_f32 v161, v169, v173, v177
  v_max_f32 v161, v161, v181
  v_mul_f32 v161, s40, v161
  v_ceil_f32 v161, v161
  v_max3_f32 v162, v170, v174, v178
  v_max_f32 v162, v162, v182
  v_mul_f32 v162, s40, v162
  v_ceil_f32 v162, v162
  v_max3_f32 v163, v171, v175, v179
  v_max_f32 v163, v163, v183
  v_mul_f32 v163, s40, v163
  v_ceil_f32 v163, v163
  v_fma_f32 v16, v16, s40, -v160
  v_fma_f32 v17, v17, s40, -v160
  v_fma_f32 v18, v18, s40, -v160
  v_fma_f32 v19, v19, s40, -v160
  v_fma_f32 v20, v20, s40, -v160
  v_fma_f32 v21, v21, s40, -v160
  v_fma_f32 v22, v22, s40, -v160
  v_fma_f32 v23, v23, s40, -v160
  buffer_load_dwordx4 a[240:243], v4, s[12:15], s78 offen offset:2048 sc1
  v_exp_f32 v16, v16
  v_exp_f32 v17, v17
  v_exp_f32 v18, v18
  v_exp_f32 v19, v19
  v_exp_f32 v20, v20
  v_exp_f32 v21, v21
  v_exp_f32 v22, v22
  v_exp_f32 v23, v23
  s_add_u32 s79, s35, 12288
  buffer_load_dwordx4 a[196:199], v4, s[12:15], s79 offen offset:0 sc1
  v_cvt_pk_bf16_f32 v16, v16, v17
  v_cvt_pk_bf16_f32 v17, v18, v19
  v_cvt_pk_bf16_f32 v18, v20, v21
  v_cvt_pk_bf16_f32 v19, v22, v23
  ds_write_b128 v8, v[16:19] offset:0
  v_fma_f32 v24, v24, s40, -v160
  v_fma_f32 v25, v25, s40, -v160
  v_fma_f32 v26, v26, s40, -v160
  v_fma_f32 v27, v27, s40, -v160
  v_fma_f32 v28, v28, s40, -v160
  v_fma_f32 v29, v29, s40, -v160
  v_fma_f32 v30, v30, s40, -v160
  v_fma_f32 v31, v31, s40, -v160
  buffer_load_dwordx4 a[220:223], v4, s[12:15], s79 offen offset:1024 sc1
  v_exp_f32 v24, v24
  v_exp_f32 v25, v25
  v_exp_f32 v26, v26
  v_exp_f32 v27, v27
  v_exp_f32 v28, v28
  v_exp_f32 v29, v29
  v_exp_f32 v30, v30
  v_exp_f32 v31, v31
  buffer_load_dwordx4 a[244:247], v4, s[12:15], s79 offen offset:2048 sc1
  v_cvt_pk_bf16_f32 v20, v24, v25
  v_cvt_pk_bf16_f32 v21, v26, v27
  v_cvt_pk_bf16_f32 v22, v28, v29
  v_cvt_pk_bf16_f32 v23, v30, v31
  ds_write_b128 v8, v[20:23] offset:4096
  v_fma_f32 v32, v32, s40, -v161
  v_fma_f32 v33, v33, s40, -v161
  v_fma_f32 v34, v34, s40, -v161
  v_fma_f32 v35, v35, s40, -v161
  v_fma_f32 v36, v36, s40, -v161
  v_fma_f32 v37, v37, s40, -v161
  v_fma_f32 v38, v38, s40, -v161
  v_fma_f32 v39, v39, s40, -v161
  s_add_u32 s64, s35, 24576
  buffer_load_dwordx4 a[200:203], v4, s[12:15], s64 offen offset:0 sc1
  v_exp_f32 v32, v32
  v_exp_f32 v33, v33
  v_exp_f32 v34, v34
  v_exp_f32 v35, v35
  v_exp_f32 v36, v36
  v_exp_f32 v37, v37
  v_exp_f32 v38, v38
  v_exp_f32 v39, v39
  buffer_load_dwordx4 a[224:227], v4, s[12:15], s64 offen offset:1024 sc1
  v_cvt_pk_bf16_f32 v32, v32, v33
  v_cvt_pk_bf16_f32 v33, v34, v35
  v_cvt_pk_bf16_f32 v34, v36, v37
  v_cvt_pk_bf16_f32 v35, v38, v39
  ds_write_b128 v8, v[32:35] offset:1024
  v_fma_f32 v40, v40, s40, -v161
  v_fma_f32 v41, v41, s40, -v161
  v_fma_f32 v42, v42, s40, -v161
  v_fma_f32 v43, v43, s40, -v161
  v_fma_f32 v44, v44, s40, -v161
  v_fma_f32 v45, v45, s40, -v161
  v_fma_f32 v46, v46, s40, -v161
  v_fma_f32 v47, v47, s40, -v161
  buffer_load_dwordx4 a[248:251], v4, s[12:15], s64 offen offset:2048 sc1
  v_exp_f32 v40, v40
  v_exp_f32 v41, v41
  v_exp_f32 v42, v42
  v_exp_f32 v43, v43
  v_exp_f32 v44, v44
  v_exp_f32 v45, v45
  v_exp_f32 v46, v46
  v_exp_f32 v47, v47
  s_add_u32 s65, s35, 36864
  buffer_load_dwordx4 a[204:207], v4, s[12:15], s65 offen offset:0 sc1
  v_cvt_pk_bf16_f32 v36, v40, v41
  v_cvt_pk_bf16_f32 v37, v42, v43
  v_cvt_pk_bf16_f32 v38, v44, v45
  v_cvt_pk_bf16_f32 v39, v46, v47
  ds_write_b128 v8, v[36:39] offset:5120
  v_fma_f32 v48, v48, s40, -v162
  v_fma_f32 v49, v49, s40, -v162
  v_fma_f32 v50, v50, s40, -v162
  v_fma_f32 v51, v51, s40, -v162
  v_fma_f32 v52, v52, s40, -v162
  v_fma_f32 v53, v53, s40, -v162
  v_fma_f32 v54, v54, s40, -v162
  v_fma_f32 v55, v55, s40, -v162
  buffer_load_dwordx4 a[228:231], v4, s[12:15], s65 offen offset:1024 sc1
  v_exp_f32 v48, v48
  v_exp_f32 v49, v49
  v_exp_f32 v50, v50
  v_exp_f32 v51, v51
  v_exp_f32 v52, v52
  v_exp_f32 v53, v53
  v_exp_f32 v54, v54
  v_exp_f32 v55, v55
  buffer_load_dwordx4 a[252:255], v4, s[12:15], s65 offen offset:2048 sc1
  v_cvt_pk_bf16_f32 v48, v48, v49
  v_cvt_pk_bf16_f32 v49, v50, v51
  v_cvt_pk_bf16_f32 v50, v52, v53
  v_cvt_pk_bf16_f32 v51, v54, v55
  ds_write_b128 v8, v[48:51] offset:2048
  v_fma_f32 v56, v56, s40, -v162
  v_fma_f32 v57, v57, s40, -v162
  v_fma_f32 v58, v58, s40, -v162
  v_fma_f32 v59, v59, s40, -v162
  v_fma_f32 v60, v60, s40, -v162
  v_fma_f32 v61, v61, s40, -v162
  v_fma_f32 v62, v62, s40, -v162
  v_fma_f32 v63, v63, s40, -v162
  s_add_u32 s66, s35, 49152
  buffer_load_dwordx4 a[208:211], v4, s[12:15], s66 offen offset:0 sc1
  v_exp_f32 v56, v56
  v_exp_f32 v57, v57
  v_exp_f32 v58, v58
  v_exp_f32 v59, v59
  v_exp_f32 v60, v60
  v_exp_f32 v61, v61
  v_exp_f32 v62, v62
  v_exp_f32 v63, v63
  buffer_load_dwordx4 a[232:235], v4, s[12:15], s66 offen offset:1024 sc1
  v_cvt_pk_bf16_f32 v52, v56, v57
  v_cvt_pk_bf16_f32 v53, v58, v59
  v_cvt_pk_bf16_f32 v54, v60, v61
  v_cvt_pk_bf16_f32 v55, v62, v63
  ds_write_b128 v8, v[52:55] offset:6144
  v_fma_f32 v64, v64, s40, -v163
  v_fma_f32 v65, v65, s40, -v163
  v_fma_f32 v66, v66, s40, -v163
  v_fma_f32 v67, v67, s40, -v163
  v_fma_f32 v68, v68, s40, -v163
  v_fma_f32 v69, v69, s40, -v163
  v_fma_f32 v70, v70, s40, -v163
  v_fma_f32 v71, v71, s40, -v163
  buffer_load_dwordx4 v[248:251], v4, s[12:15], s66 offen offset:2048 sc1
  v_exp_f32 v64, v64
  v_exp_f32 v65, v65
  v_exp_f32 v66, v66
  v_exp_f32 v67, v67
  v_exp_f32 v68, v68
  v_exp_f32 v69, v69
  v_exp_f32 v70, v70
  v_exp_f32 v71, v71
  s_add_u32 s67, s35, 61440
  buffer_load_dwordx4 a[212:215], v4, s[12:15], s67 offen offset:0 sc1
  v_cvt_pk_bf16_f32 v64, v64, v65
  v_cvt_pk_bf16_f32 v65, v66, v67
  v_cvt_pk_bf16_f32 v66, v68, v69
  v_cvt_pk_bf16_f32 v67, v70, v71
  ds_write_b128 v8, v[64:67] offset:3072
  v_fma_f32 v72, v72, s40, -v163
  v_fma_f32 v73, v73, s40, -v163
  v_fma_f32 v74, v74, s40, -v163
  v_fma_f32 v75, v75, s40, -v163
  v_fma_f32 v76, v76, s40, -v163
  v_fma_f32 v77, v77, s40, -v163
  v_fma_f32 v78, v78, s40, -v163
  v_fma_f32 v79, v79, s40, -v163
  buffer_load_dwordx4 a[236:239], v4, s[12:15], s67 offen offset:1024 sc1
  v_exp_f32 v72, v72
  v_exp_f32 v73, v73
  v_exp_f32 v74, v74
  v_exp_f32 v75, v75
  v_exp_f32 v76, v76
  v_exp_f32 v77, v77
  v_exp_f32 v78, v78
  v_exp_f32 v79, v79
  buffer_load_dwordx4 v[252:255], v4, s[12:15], s67 offen offset:2048 sc1
  v_cvt_pk_bf16_f32 v68, v72, v73
  v_cvt_pk_bf16_f32 v69, v74, v75
  v_cvt_pk_bf16_f32 v70, v76, v77
  v_cvt_pk_bf16_f32 v71, v78, v79
  ds_write_b128 v8, v[68:71] offset:7168
  s_waitcnt lgkmcnt(0)
  s_barrier
  ds_read_b128 v[128:131], v4 offset:24576
  ds_read_b128 v[132:135], v4 offset:25600
  ds_read_b128 v[136:139], v4 offset:26624
  ds_read_b128 v[140:143], v4 offset:27648
  ds_read_b128 v[176:179], v9 offset:24576
  ds_read_b128 v[144:147], v4 offset:28672
  ds_read_b128 v[148:151], v4 offset:29696
  ds_read_b128 v[152:155], v4 offset:30720
  ds_read_b128 v[156:159], v4 offset:31744
  ds_read_b128 v[180:183], v9 offset:28672
  s_waitcnt vmcnt(41)
  s_waitcnt lgkmcnt(9)
  v_mfma_f32_16x16x32_bf16 v[80:83], a[96:99], v[128:131], 0
  v_mfma_f32_16x16x32_bf16 v[84:87], a[100:103], v[128:131], 0
  v_mfma_f32_16x16x32_bf16 v[88:91], a[104:107], v[128:131], 0
  s_add_u32 s68, s38, 0
  buffer_load_dwordx4 a[0:3], v4, s[12:15], s68 offen offset:0 sc1
  s_waitcnt lgkmcnt(8)
  v_mfma_f32_16x16x32_bf16 v[92:95], a[96:99], v[132:135], 0
  v_mfma_f32_16x16x32_bf16 v[96:99], a[100:103], v[132:135], 0
  v_mfma_f32_16x16x32_bf16 v[100:103], a[104:107], v[132:135], 0
  buffer_load_dwordx4 a[12:15], v4, s[12:15], s68 offen offset:1024 sc1
  s_waitcnt lgkmcnt(7)
  v_mfma_f32_16x16x32_bf16 v[104:107], a[96:99], v[136:139], 0
  v_mfma_f32_16x16x32_bf16 v[108:111], a[100:103], v[136:139], 0
  v_mfma_f32_16x16x32_bf16 v[112:115], a[104:107], v[136:139], 0
  buffer_load_dwordx4 a[24:27], v4, s[12:15], s68 offen offset:2048 sc1
  s_waitcnt lgkmcnt(6)
  v_mfma_f32_16x16x32_bf16 v[116:119], a[96:99], v[140:143], 0
  v_mfma_f32_16x16x32_bf16 v[120:123], a[100:103], v[140:143], 0
  v_mfma_f32_16x16x32_bf16 v[124:127], a[104:107], v[140:143], 0
  buffer_load_dwordx4 a[36:39], v4, s[12:15], s68 offen offset:3072 sc1
  s_waitcnt lgkmcnt(5)
  v_mfma_f32_16x16x32_bf16 v[168:171], v[164:167], v[176:179], 0
  ds_read_b128 v[128:131], v4 offset:32768
  ds_read_b128 v[132:135], v4 offset:33792
  ds_read_b128 v[136:139], v4 offset:34816
  ds_read_b128 v[140:143], v4 offset:35840
  ds_read_b128 v[176:179], v9 offset:32768
  s_waitcnt vmcnt(42)
  s_waitcnt lgkmcnt(9)
  v_mfma_f32_16x16x32_bf16 v[80:83], a[108:111], v[144:147], v[80:83]
  v_mfma_f32_16x16x32_bf16 v[84:87], a[112:115], v[144:147], v[84:87]
  v_mfma_f32_16x16x32_bf16 v[88:91], a[116:119], v[144:147], v[88:91]
  s_add_u32 s69, s38, 4096
  buffer_load_dwordx4 a[48:51], v4, s[12:15], s69 offen offset:0 sc1
  s_waitcnt lgkmcnt(8)
  v_mfma_f32_16x16x32_bf16 v[92:95], a[108:111], v[148:151], v[92:95]
  v_mfma_f32_16x16x32_bf16 v[96:99], a[112:115], v[148:151], v[96:99]
  v_mfma_f32_16x16x32_bf16 v[100:103], a[116:119], v[148:151], v[100:103]
  buffer_load_dwordx4 a[60:63], v4, s[12:15], s69 offen offset:1024 sc1
  s_waitcnt lgkmcnt(7)
  v_mfma_f32_16x16x32_bf16 v[104:107], a[108:111], v[152:155], v[104:107]
  v_mfma_f32_16x16x32_bf16 v[108:111], a[112:115], v[152:155], v[108:111]
  v_mfma_f32_16x16x32_bf16 v[112:115], a[116:119], v[152:155], v[112:115]
  buffer_load_dwordx4 a[72:75], v4, s[12:15], s69 offen offset:2048 sc1
  s_waitcnt lgkmcnt(6)
  v_mfma_f32_16x16x32_bf16 v[116:119], a[108:111], v[156:159], v[116:119]
  v_mfma_f32_16x16x32_bf16 v[120:123], a[112:115], v[156:159], v[120:123]
  v_mfma_f32_16x16x32_bf16 v[124:127], a[116:119], v[156:159], v[124:127]
  buffer_load_dwordx4 a[84:87], v4, s[12:15], s69 offen offset:3072 sc1
  s_waitcnt lgkmcnt(5)
  v_mfma_f32_16x16x32_bf16 v[168:171], v[164:167], v[180:183], v[168:171]
  ds_read_b128 v[144:147], v4 offset:36864
  ds_read_b128 v[148:151], v4 offset:37888
  ds_read_b128 v[152:155], v4 offset:38912
  ds_read_b128 v[156:159], v4 offset:39936
  ds_read_b128 v[180:183], v9 offset:36864
  s_waitcnt vmcnt(43)
  s_waitcnt lgkmcnt(9)
  v_mfma_f32_16x16x32_bf16 v[80:83], a[120:123], v[128:131], v[80:83]
  v_mfma_f32_16x16x32_bf16 v[84:87], a[124:127], v[128:131], v[84:87]
  v_mfma_f32_16x16x32_bf16 v[88:91], a[128:131], v[128:131], v[88:91]
  s_add_u32 s70, s38, 12288
  buffer_load_dwordx4 a[4:7], v4, s[12:15], s70 offen offset:0 sc1
  s_waitcnt lgkmcnt(8)
  v_mfma_f32_16x16x32_bf16 v[92:95], a[120:123], v[132:135], v[92:95]
  v_mfma_f32_16x16x32_bf16 v[96:99], a[124:127], v[132:135], v[96:99]
  v_mfma_f32_16x16x32_bf16 v[100:103], a[128:131], v[132:135], v[100:103]
  buffer_load_dwordx4 a[16:19], v4, s[12:15], s70 offen offset:1024 sc1
  s_waitcnt lgkmcnt(7)
  v_mfma_f32_16x16x32_bf16 v[104:107], a[120:123], v[136:139], v[104:107]
  v_mfma_f32_16x16x32_bf16 v[108:111], a[124:127], v[136:139], v[108:111]
  v_mfma_f32_16x16x32_bf16 v[112:115], a[128:131], v[136:139], v[112:115]
  buffer_load_dwordx4 a[28:31], v4, s[12:15], s70 offen offset:2048 sc1
  s_waitcnt lgkmcnt(6)
  v_mfma_f32_16x16x32_bf16 v[116:119], a[120:123], v[140:143], v[116:119]
  v_mfma_f32_16x16x32_bf16 v[120:123], a[124:127], v[140:143], v[120:123]
  v_mfma_f32_16x16x32_bf16 v[124:127], a[128:131], v[140:143], v[124:127]
  buffer_load_dwordx4 a[40:43], v4, s[12:15], s70 offen offset:3072 sc1
  s_waitcnt lgkmcnt(5)
  v_mfma_f32_16x16x32_bf16 v[168:171], v[164:167], v[176:179], v[168:171]
  s_lshr_b32 s26, s22, 1
  s_lshl_b32 s26, s26, 6
  s_lshl_b32 s27, s24, 2
  s_add_u32 s26, s26, s27
  s_lshl_b32 s27, s20, 2
  s_add_u32 s27, s27, s23
  s_mul_i32 s27, s27, 49152
  s_add_u32 s27, s27, 9175040
  s_and_b32 s28, s22, 1
  s_mul_i32 s29, s28, 6144
  s_add_u32 s32, s29, s27
  s_mul_i32 s56, s3, 3
  s_add_u32 s57, s56, 0
  s_lshr_b32 s58, s57, 1
  s_lshl_b32 s58, s58, 10
  s_and_b32 s57, s57, 1
  s_lshl_b32 s57, s57, 3
  s_add_u32 s58, s58, s57
  s_add_u32 s58, s58, 65536
  v_add_u32 v12, s58, v4
  s_add_u32 s57, s56, 1
  s_lshr_b32 s58, s57, 1
  s_lshl_b32 s58, s58, 10
  s_and_b32 s57, s57, 1
  s_lshl_b32 s57, s57, 3
  s_add_u32 s58, s58, s57
  s_add_u32 s58, s58, 65536
  v_add_u32 v13, s58, v4
  s_add_u32 s57, s56, 2
  s_lshr_b32 s58, s57, 1
  s_lshl_b32 s58, s58, 10
  s_and_b32 s57, s57, 1
  s_lshl_b32 s57, s57, 3
  s_add_u32 s58, s58, s57
  s_add_u32 s58, s58, 65536
  v_add_u32 v14, s58, v4
  s_mul_i32 s58, s3, 6144
  s_add_u32 s58, s58, 65536
  v_add_u32 v15, s58, v4
  ds_read_b128 v[128:131], v4 offset:40960
  ds_read_b128 v[132:135], v4 offset:41984
  ds_read_b128 v[136:139], v4 offset:43008
  ds_read_b128 v[140:143], v4 offset:44032
  ds_read_b128 v[176:179], v9 offset:40960
  s_waitcnt vmcnt(44)
  s_waitcnt lgkmcnt(9)
  v_mfma_f32_16x16x32_bf16 v[80:83], a[132:135], v[144:147], v[80:83]
  v_mfma_f32_16x16x32_bf16 v[84:87], a[136:139], v[144:147], v[84:87]
  v_mfma_f32_16x16x32_bf16 v[88:91], a[140:143], v[144:147], v[88:91]
  s_add_u32 s71, s38, 16384
  buffer_load_dwordx4 a[52:55], v4, s[12:15], s71 offen offset:0 sc1
  s_waitcnt lgkmcnt(8)
  v_mfma_f32_16x16x32_bf16 v[92:95], a[132:135], v[148:151], v[92:95]
  v_mfma_f32_16x16x32_bf16 v[96:99], a[136:139], v[148:151], v[96:99]
  v_mfma_f32_16x16x32_bf16 v[100:103], a[140:143], v[148:151], v[100:103]
  buffer_load_dwordx4 a[64:67], v4, s[12:15], s71 offen offset:1024 sc1
  s_waitcnt lgkmcnt(7)
  v_mfma_f32_16x16x32_bf16 v[104:107], a[132:135], v[152:155], v[104:107]
  v_mfma_f32_16x16x32_bf16 v[108:111], a[136:139], v[152:155], v[108:111]
  v_mfma_f32_16x16x32_bf16 v[112:115], a[140:143], v[152:155], v[112:115]
  buffer_load_dwordx4 a[76:79], v4, s[12:15], s71 offen offset:2048 sc1
  s_waitcnt lgkmcnt(6)
  v_mfma_f32_16x16x32_bf16 v[116:119], a[132:135], v[156:159], v[116:119]
  v_mfma_f32_16x16x32_bf16 v[120:123], a[136:139], v[156:159], v[120:123]
  v_mfma_f32_16x16x32_bf16 v[124:127], a[140:143], v[156:159], v[124:127]
  buffer_load_dwordx4 a[88:91], v4, s[12:15], s71 offen offset:3072 sc1
  s_waitcnt lgkmcnt(5)
  v_mfma_f32_16x16x32_bf16 v[168:171], v[164:167], v[180:183], v[168:171]
  s_waitcnt vmcnt(34)
  v_readfirstlane_b32 s56, v5
  s_cmp_ge_u32 s56, 32
  s_cselect_b32 s63, s63, 0
  v_mov_b32 v172, v160
  s_cmp_eq_u32 s3, 1
  s_cselect_b64 vcc, -1, 0
  v_cndmask_b32 v172, v172, v161, vcc
  s_cmp_eq_u32 s3, 2
  s_cselect_b64 vcc, -1, 0
  v_cndmask_b32 v172, v172, v162, vcc
  s_cmp_eq_u32 s3, 3
  s_cselect_b64 vcc, -1, 0
  v_cndmask_b32 v172, v172, v163, vcc
  s_lshl_b32 s27, s23, 1
  s_add_u32 s27, s27, s28
  s_lshl_b32 s27, s27, 14
  s_add_u32 s26, s26, s3
  s_lshl_b32 s26, s26, 7
  s_add_u32 s27, s27, s26
  s_add_u32 s27, s27, 4325376
  v_lshlrev_b32 v10, 3, v1
  ds_read_b128 v[144:147], v4 offset:45056
  ds_read_b128 v[148:151], v4 offset:46080
  ds_read_b128 v[152:155], v4 offset:47104
  ds_read_b128 v[156:159], v4 offset:48128
  ds_read_b128 v[180:183], v9 offset:45056
  s_waitcnt vmcnt(45)
  s_waitcnt lgkmcnt(9)
  v_mfma_f32_16x16x32_bf16 v[80:83], a[144:147], v[128:131], v[80:83]
  v_mfma_f32_16x16x32_bf16 v[84:87], a[148:151], v[128:131], v[84:87]
  v_mfma_f32_16x16x32_bf16 v[88:91], a[152:155], v[128:131], v[88:91]
  s_add_u32 s72, s38, 24576
  buffer_load_dwordx4 a[8:11], v4, s[12:15], s72 offen offset:0 sc1
  s_waitcnt lgkmcnt(8)
  v_mfma_f32_16x16x32_bf16 v[92:95], a[144:147], v[132:135], v[92:95]
  v_mfma_f32_16x16x32_bf16 v[96:99], a[148:151], v[132:135], v[96:99]
  v_mfma_f32_16x16x32_bf16 v[100:103], a[152:155], v[132:135], v[100:103]
  buffer_load_dwordx4 a[20:23], v4, s[12:15], s72 offen offset:1024 sc1
  s_waitcnt lgkmcnt(7)
  v_mfma_f32_16x16x32_bf16 v[104:107], a[144:147], v[136:139], v[104:107]
  v_mfma_f32_16x16x32_bf16 v[108:111], a[148:151], v[136:139], v[108:111]
  v_mfma_f32_16x16x32_bf16 v[112:115], a[152:155], v[136:139], v[112:115]
  buffer_load_dwordx4 a[32:35], v4, s[12:15], s72 offen offset:2048 sc1
  s_waitcnt lgkmcnt(6)
  v_mfma_f32_16x16x32_bf16 v[116:119], a[144:147], v[140:143], v[116:119]
  v_mfma_f32_16x16x32_bf16 v[120:123], a[148:151], v[140:143], v[120:123]
  v_mfma_f32_16x16x32_bf16 v[124:127], a[152:155], v[140:143], v[124:127]
  buffer_load_dwordx4 a[44:47], v4, s[12:15], s72 offen offset:3072 sc1
  s_waitcnt lgkmcnt(5)
  v_mfma_f32_16x16x32_bf16 v[168:171], v[164:167], v[176:179], v[168:171]
  ds_read_b128 v[128:131], v4 offset:49152
  ds_read_b128 v[132:135], v4 offset:50176
  ds_read_b128 v[136:139], v4 offset:51200
  ds_read_b128 v[140:143], v4 offset:52224
  ds_read_b128 v[176:179], v9 offset:49152
  s_waitcnt vmcnt(46)
  s_waitcnt lgkmcnt(9)
  v_mfma_f32_16x16x32_bf16 v[80:83], a[156:159], v[144:147], v[80:83]
  v_mfma_f32_16x16x32_bf16 v[84:87], a[160:163], v[144:147], v[84:87]
  v_mfma_f32_16x16x32_bf16 v[88:91], a[164:167], v[144:147], v[88:91]
  s_add_u32 s73, s38, 28672
  buffer_load_dwordx4 a[56:59], v4, s[12:15], s73 offen offset:0 sc1
  s_waitcnt lgkmcnt(8)
  v_mfma_f32_16x16x32_bf16 v[92:95], a[156:159], v[148:151], v[92:95]
  v_mfma_f32_16x16x32_bf16 v[96:99], a[160:163], v[148:151], v[96:99]
  v_mfma_f32_16x16x32_bf16 v[100:103], a[164:167], v[148:151], v[100:103]
  buffer_load_dwordx4 a[68:71], v4, s[12:15], s73 offen offset:1024 sc1
  s_waitcnt lgkmcnt(7)
  v_mfma_f32_16x16x32_bf16 v[104:107], a[156:159], v[152:155], v[104:107]
  v_mfma_f32_16x16x32_bf16 v[108:111], a[160:163], v[152:155], v[108:111]
  v_mfma_f32_16x16x32_bf16 v[112:115], a[164:167], v[152:155], v[112:115]
  buffer_load_dwordx4 a[80:83], v4, s[12:15], s73 offen offset:2048 sc1
  s_waitcnt lgkmcnt(6)
  v_mfma_f32_16x16x32_bf16 v[116:119], a[156:159], v[156:159], v[116:119]
  v_mfma_f32_16x16x32_bf16 v[120:123], a[160:163], v[156:159], v[120:123]
  v_mfma_f32_16x16x32_bf16 v[124:127], a[164:167], v[156:159], v[124:127]
  buffer_load_dwordx4 a[92:95], v4, s[12:15], s73 offen offset:3072 sc1
  s_waitcnt lgkmcnt(5)
  v_mfma_f32_16x16x32_bf16 v[168:171], v[164:167], v[180:183], v[168:171]
  ds_read_b128 v[144:147], v4 offset:53248
  ds_read_b128 v[148:151], v4 offset:54272
  ds_read_b128 v[152:155], v4 offset:55296
  ds_read_b128 v[156:159], v4 offset:56320
  ds_read_b128 v[180:183], v9 offset:53248
  s_waitcnt vmcnt(47)
  s_waitcnt lgkmcnt(9)
  v_mfma_f32_16x16x32_bf16 v[80:83], a[168:171], v[128:131], v[80:83]
  v_mfma_f32_16x16x32_bf16 v[84:87], a[172:175], v[128:131], v[84:87]
  v_mfma_f32_16x16x32_bf16 v[88:91], a[176:179], v[128:131], v[88:91]
  s_waitcnt lgkmcnt(8)
  v_mfma_f32_16x16x32_bf16 v[92:95], a[168:171], v[132:135], v[92:95]
  v_mfma_f32_16x16x32_bf16 v[96:99], a[172:175], v[132:135], v[96:99]
  v_mfma_f32_16x16x32_bf16 v[100:103], a[176:179], v[132:135], v[100:103]
  s_waitcnt lgkmcnt(7)
  v_mfma_f32_16x16x32_bf16 v[104:107], a[168:171], v[136:139], v[104:107]
  v_mfma_f32_16x16x32_bf16 v[108:111], a[172:175], v[136:139], v[108:111]
  v_mfma_f32_16x16x32_bf16 v[112:115], a[176:179], v[136:139], v[112:115]
  s_waitcnt lgkmcnt(6)
  v_mfma_f32_16x16x32_bf16 v[116:119], a[168:171], v[140:143], v[116:119]
  v_mfma_f32_16x16x32_bf16 v[120:123], a[172:175], v[140:143], v[120:123]
  v_mfma_f32_16x16x32_bf16 v[124:127], a[176:179], v[140:143], v[124:127]
  s_waitcnt lgkmcnt(5)
  v_mfma_f32_16x16x32_bf16 v[168:171], v[164:167], v[176:179], v[168:171]
  s_waitcnt vmcnt(44)
  s_waitcnt lgkmcnt(4)
  v_mfma_f32_16x16x32_bf16 v[80:83], a[180:183], v[144:147], v[80:83]
  v_mfma_f32_16x16x32_bf16 v[84:87], a[184:187], v[144:147], v[84:87]
  v_mfma_f32_16x16x32_bf16 v[88:91], a[188:191], v[144:147], v[88:91]
  s_waitcnt lgkmcnt(3)
  v_mfma_f32_16x16x32_bf16 v[92:95], a[180:183], v[148:151], v[92:95]
  v_mfma_f32_16x16x32_bf16 v[96:99], a[184:187], v[148:151], v[96:99]
  v_mfma_f32_16x16x32_bf16 v[100:103], a[188:191], v[148:151], v[100:103]
  s_waitcnt lgkmcnt(2)
  v_mfma_f32_16x16x32_bf16 v[104:107], a[180:183], v[152:155], v[104:107]
  v_mfma_f32_16x16x32_bf16 v[108:111], a[184:187], v[152:155], v[108:111]
  v_mfma_f32_16x16x32_bf16 v[112:115], a[188:191], v[152:155], v[112:115]
  s_waitcnt lgkmcnt(1)
  v_mfma_f32_16x16x32_bf16 v[116:119], a[180:183], v[156:159], v[116:119]
  v_mfma_f32_16x16x32_bf16 v[120:123], a[184:187], v[156:159], v[120:123]
  v_mfma_f32_16x16x32_bf16 v[124:127], a[188:191], v[156:159], v[124:127]
  s_waitcnt lgkmcnt(0)
  v_mfma_f32_16x16x32_bf16 v[168:171], v[164:167], v[180:183], v[168:171]
  s_nop 4
  v_cvt_pk_bf16_f32 v80, v80, v81
  v_cvt_pk_bf16_f32 v81, v82, v83
  ds_write_b64 v12, v[80:81] offset:0
  v_cvt_pk_bf16_f32 v84, v84, v85
  v_cvt_pk_bf16_f32 v85, v86, v87
  ds_write_b64 v13, v[84:85] offset:0
  v_cvt_pk_bf16_f32 v88, v88, v89
  v_cvt_pk_bf16_f32 v89, v90, v91
  ds_write_b64 v14, v[88:89] offset:0
  v_cvt_pk_bf16_f32 v92, v92, v93
  v_cvt_pk_bf16_f32 v93, v94, v95
  ds_write_b64 v12, v[92:93] offset:6144
  v_cvt_pk_bf16_f32 v96, v96, v97
  v_cvt_pk_bf16_f32 v97, v98, v99
  ds_write_b64 v13, v[96:97] offset:6144
  v_cvt_pk_bf16_f32 v100, v100, v101
  v_cvt_pk_bf16_f32 v101, v102, v103
  ds_write_b64 v14, v[100:101] offset:6144
  v_cvt_pk_bf16_f32 v104, v104, v105
  v_cvt_pk_bf16_f32 v105, v106, v107
  ds_write_b64 v12, v[104:105] offset:12288
  v_cvt_pk_bf16_f32 v108, v108, v109
  v_cvt_pk_bf16_f32 v109, v110, v111
  ds_write_b64 v13, v[108:109] offset:12288
  v_cvt_pk_bf16_f32 v112, v112, v113
  v_cvt_pk_bf16_f32 v113, v114, v115
  ds_write_b64 v14, v[112:113] offset:12288
  v_cvt_pk_bf16_f32 v116, v116, v117
  v_cvt_pk_bf16_f32 v117, v118, v119
  ds_write_b64 v12, v[116:117] offset:18432
  v_cvt_pk_bf16_f32 v120, v120, v121
  v_cvt_pk_bf16_f32 v121, v122, v123
  ds_write_b64 v13, v[120:121] offset:18432
  v_cvt_pk_bf16_f32 v124, v124, v125
  v_cvt_pk_bf16_f32 v125, v126, v127
  ds_write_b64 v14, v[124:125] offset:18432
  v_mov_b32 v173, v168
  s_mov_b64 exec, 0xffff
  buffer_store_dwordx2 v[172:173], v10, s[12:15], s27 offen sc1
  s_mov_b64 exec, -1
  s_mul_i32 s52, s3, 12288
  s_add_u32 s52, s52, s32
  s_add_u32 s53, s52, 4096
  s_waitcnt lgkmcnt(0)
  s_barrier
  ds_read_b128 v[128:131], v15 offset:0
  ds_read_b128 v[132:135], v15 offset:1024
  ds_read_b128 v[136:139], v15 offset:2048
  ds_read_b128 v[140:143], v15 offset:3072
  ds_read_b128 v[144:147], v15 offset:4096
  ds_read_b128 v[148:151], v15 offset:5120
  s_waitcnt lgkmcnt(5)
  buffer_store_dwordx4 v[128:131], v4, s[12:15], s52 offen offset:0 sc1
  s_waitcnt lgkmcnt(4)
  buffer_store_dwordx4 v[132:135], v4, s[12:15], s52 offen offset:1024 sc1
  s_waitcnt lgkmcnt(3)
  buffer_store_dwordx4 v[136:139], v4, s[12:15], s52 offen offset:2048 sc1
  s_waitcnt lgkmcnt(2)
  buffer_store_dwordx4 v[140:143], v4, s[12:15], s52 offen offset:3072 sc1
  s_waitcnt lgkmcnt(1)
  buffer_store_dwordx4 v[144:147], v4, s[12:15], s53 offen offset:0 sc1
  s_waitcnt lgkmcnt(0)
  buffer_store_dwordx4 v[148:151], v4, s[12:15], s53 offen offset:1024 sc1
  s_lshl_b32 s44, s28, 2
  s_add_u32 s44, s44, s23
  s_lshl_b32 s56, s43, 7
  s_lshl_b32 s57, s44, 2
  s_add_u32 s56, s56, s57
  s_add_u32 s56, s56, 36864
  v_mov_b32 v10, 0
  v_mov_b32 v11, 1
  s_cmp_lg_u32 s3, 0
  s_waitcnt vmcnt(0)
  s_barrier
  s_cbranch_scc1 mega_kernel_puba
  s_mov_b64 exec, 1
  s_cmp_eq_u32 s63, 1
  s_cbranch_scc1 mega_kernel_dfpa
  buffer_store_dword v11, v10, s[12:15], s56 offen sc1
  s_branch mega_kernel_depa
mega_kernel_dfpa:
  buffer_store_dword v11, v10, s[12:15], s56 offen
mega_kernel_depa:
  s_mov_b64 exec, -1
mega_kernel_puba:
  s_lshr_b32 s34, s20, 4
  s_lshl_b32 s34, s34, 5
  s_and_b32 s56, s20, 15
  s_add_u32 s34, s34, s56
  s_mul_i32 s34, s34, 24576
  s_add_u32 s34, s34, 4456448
  s_lshr_b32 s40, s3, 1
  s_min_u32 s41, s3, 2
  s_mul_i32 s48, s37, 3
  s_add_u32 s48, s48, s41
  s_mul_i32 s47, s36, 24576
  s_lshl_b32 s25, s48, 10
  s_and_b32 s56, s36, 1
  s_mul_i32 s56, s56, 393216
  s_add_u32 s25, s25, s56
  s_add_u32 s25, s25, s34
  s_add_u32 s31, s25, 12288
  s_lshl_b32 s49, s48, 6
  s_add_u32 s47, s47, s49
  s_add_u32 s49, s47, 12288
  s_lshr_b32 s26, s36, 5
  s_mul_i32 s26, s26, 9216
  s_lshl_b32 s27, s48, 7
  s_add_u32 s26, s26, s27
  s_add_u32 s26, s26, 3072
  v_mul_u32_u24 v6, 768, v2
  v_lshl_add_u32 v6, v3, 4, v6
  v_lshlrev_b32 v7, 5, v3
  s_lshl_b32 s27, s40, 14
  s_lshl_b32 s28, s36, 8
  s_add_u32 s27, s27, s28
  s_add_u32 s27, s27, 4325376
  v_lshlrev_b32 v12, 3, v2
  s_mul_i32 s28, s3, 3072
  s_mul_i32 s29, s20, 196608
  s_add_u32 s29, s29, s28
  s_and_b32 s28, s36, 1
  s_mul_i32 s28, s28, 24576
  s_add_u32 s29, s29, s28
  s_add_u32 s29, s29, 9175040
  s_lshr_b32 s30, s36, 1
  v_and_b32 v10, 3, v1
  s_lshr_b32 s57, s3, 1
  s_lshl_b32 s57, s57, 4
  v_lshlrev_b32 v10, 2, v10
  s_lshl_b32 s58, s30, 7
  s_add_u32 s58, s58, s57
  v_add_u32 v10, s58, v10
  s_mov_b32 s56, 36864
  s_mov_b32 s57, 0x100000
mega_kernel_plw:
  buffer_load_dword v11, v10, s[12:15], s56 offen sc1
  s_waitcnt vmcnt(0)
  v_cmp_ne_u32 vcc, 1, v11
  s_sub_u32 s57, s57, 1
  s_cbranch_scc1 mega_kernel_pdw
  s_cbranch_vccz mega_kernel_pdw
  s_sleep 1
  s_branch mega_kernel_plw
mega_kernel_pdw:
  buffer_load_dwordx2 v[160:161], v12, s[12:15], s27 offen offset:0 sc1
  buffer_load_dwordx2 v[168:169], v12, s[12:15], s27 offen offset:128 sc1
  s_add_u32 s27, s27, 32768
  buffer_load_dwordx2 v[162:163], v12, s[12:15], s27 offen offset:0 sc1
  buffer_load_dwordx2 v[170:171], v12, s[12:15], s27 offen offset:128 sc1
  s_add_u32 s27, s27, 32768
  buffer_load_dwordx2 v[164:165], v12, s[12:15], s27 offen offset:0 sc1
  buffer_load_dwordx2 v[172:173], v12, s[12:15], s27 offen offset:128 sc1
  s_add_u32 s27, s27, 32768
  buffer_load_dwordx2 v[166:167], v12, s[12:15], s27 offen offset:0 sc1
  buffer_load_dwordx2 v[174:175], v12, s[12:15], s27 offen offset:128 sc1
  s_add_u32 s27, s27, 32768
  s_add_u32 s64, s29, 0
  buffer_load_dwordx4 v[64:67], v4, s[12:15], s64 offen offset:0 sc1
  buffer_load_dwordx4 v[96:99], v4, s[12:15], s64 offen offset:1024 sc1
  s_add_u32 s65, s29, 49152
  buffer_load_dwordx4 v[68:71], v4, s[12:15], s65 offen offset:0 sc1
  buffer_load_dwordx4 v[100:103], v4, s[12:15], s65 offen offset:1024 sc1
  s_add_u32 s66, s29, 98304
  buffer_load_dwordx4 v[72:75], v4, s[12:15], s66 offen offset:0 sc1
  buffer_load_dwordx4 v[104:107], v4, s[12:15], s66 offen offset:1024 sc1
  s_add_u32 s67, s29, 147456
  buffer_load_dwordx4 v[76:79], v4, s[12:15], s67 offen offset:0 sc1
  buffer_load_dwordx4 v[108:111], v4, s[12:15], s67 offen offset:1024 sc1
  s_add_u32 s68, s29, 12288
  buffer_load_dwordx4 v[80:83], v4, s[12:15], s68 offen offset:0 sc1
  buffer_load_dwordx4 v[112:115], v4, s[12:15], s68 offen offset:1024 sc1
  s_add_u32 s69, s29, 61440
  buffer_load_dwordx4 v[84:87], v4, s[12:15], s69 offen offset:0 sc1
  buffer_load_dwordx4 v[116:119], v4, s[12:15], s69 offen offset:1024 sc1
  s_add_u32 s70, s29, 110592
  buffer_load_dwordx4 v[88:91], v4, s[12:15], s70 offen offset:0 sc1
  buffer_load_dwordx4 v[120:123], v4, s[12:15], s70 offen offset:1024 sc1
  s_add_u32 s71, s29, 159744
  buffer_load_dwordx4 v[92:95], v4, s[12:15], s71 offen offset:0 sc1
  buffer_load_dwordx4 v[124:127], v4, s[12:15], s71 offen offset:1024 sc1
  s_waitcnt vmcnt(16)
  v_max3_f32 v184, v160, v162, v164
  v_max_f32 v184, v184, v166
  v_sub_f32 v160, v160, v184
  v_sub_f32 v162, v162, v184
  v_sub_f32 v164, v164, v184
  v_sub_f32 v166, v166, v184
  v_exp_f32 v160, v160
  v_exp_f32 v162, v162
  v_exp_f32 v164, v164
  v_exp_f32 v166, v166
  s_nop 0
  v_mul_f32 v184, v160, v161
  v_mul_f32 v185, v162, v163
  v_fmac_f32 v184, v164, v165
  v_fmac_f32 v185, v166, v167
  v_add_f32 v184, v184, v185
  v_rcp_f32 v184, v184
  s_nop 0
  v_mov_b32 v176, v184
  v_and_b32 v161, 0xffff0000, v160
  v_lshrrev_b32 v160, 16, v160
  v_and_b32 v163, 0xffff0000, v162
  v_lshrrev_b32 v162, 16, v162
  v_and_b32 v165, 0xffff0000, v164
  v_lshrrev_b32 v164, 16, v164
  v_and_b32 v167, 0xffff0000, v166
  v_lshrrev_b32 v166, 16, v166
  v_max3_f32 v184, v168, v170, v172
  v_max_f32 v184, v184, v174
  v_sub_f32 v168, v168, v184
  v_sub_f32 v170, v170, v184
  v_sub_f32 v172, v172, v184
  v_sub_f32 v174, v174, v184
  v_exp_f32 v168, v168
  v_exp_f32 v170, v170
  v_exp_f32 v172, v172
  v_exp_f32 v174, v174
  s_nop 0
  v_mul_f32 v184, v168, v169
  v_mul_f32 v185, v170, v171
  v_fmac_f32 v184, v172, v173
  v_fmac_f32 v185, v174, v175
  v_add_f32 v184, v184, v185
  v_rcp_f32 v184, v184
  s_nop 0
  v_mov_b32 v177, v184
  v_and_b32 v169, 0xffff0000, v168
  v_lshrrev_b32 v168, 16, v168
  v_and_b32 v171, 0xffff0000, v170
  v_lshrrev_b32 v170, 16, v170
  v_and_b32 v173, 0xffff0000, v172
  v_lshrrev_b32 v172, 16, v172
  v_and_b32 v175, 0xffff0000, v174
  v_lshrrev_b32 v174, 16, v174
  s_waitcnt vmcnt(9)
  v_dot2_f32_bf16 v184, v64, v160, 0
  v_dot2_f32_bf16 v185, v64, v161, 0
  v_dot2_f32_bf16 v186, v65, v160, 0
  v_dot2_f32_bf16 v187, v65, v161, 0
  v_dot2_f32_bf16 v188, v66, v160, 0
  v_dot2_f32_bf16 v189, v66, v161, 0
  v_dot2_f32_bf16 v190, v67, v160, 0
  v_dot2_f32_bf16 v191, v67, v161, 0
  buffer_load_dwordx4 v[128:131], v4, s[12:15], s64 offen offset:2048 sc1
  v_dot2_f32_bf16 v184, v68, v162, v184
  v_dot2_f32_bf16 v185, v68, v163, v185
  v_dot2_f32_bf16 v186, v69, v162, v186
  v_dot2_f32_bf16 v187, v69, v163, v187
  v_dot2_f32_bf16 v188, v70, v162, v188
  v_dot2_f32_bf16 v189, v70, v163, v189
  v_dot2_f32_bf16 v190, v71, v162, v190
  v_dot2_f32_bf16 v191, v71, v163, v191
  buffer_load_dwordx4 v[132:135], v4, s[12:15], s65 offen offset:2048 sc1
  v_dot2_f32_bf16 v184, v72, v164, v184
  v_dot2_f32_bf16 v185, v72, v165, v185
  v_dot2_f32_bf16 v186, v73, v164, v186
  v_dot2_f32_bf16 v187, v73, v165, v187
  v_dot2_f32_bf16 v188, v74, v164, v188
  v_dot2_f32_bf16 v189, v74, v165, v189
  v_dot2_f32_bf16 v190, v75, v164, v190
  v_dot2_f32_bf16 v191, v75, v165, v191
  buffer_load_dwordx4 v[136:139], v4, s[12:15], s66 offen offset:2048 sc1
  v_dot2_f32_bf16 v184, v76, v166, v184
  v_dot2_f32_bf16 v185, v76, v167, v185
  v_dot2_f32_bf16 v186, v77, v166, v186
  v_dot2_f32_bf16 v187, v77, v167, v187
  v_dot2_f32_bf16 v188, v78, v166, v188
  v_dot2_f32_bf16 v189, v78, v167, v189
  v_dot2_f32_bf16 v190, v79, v166, v190
  v_dot2_f32_bf16 v191, v79, v167, v191
  buffer_load_dwordx4 v[140:143], v4, s[12:15], s67 offen offset:2048 sc1
  s_nop 2
  v_mul_f32 v184, v184, v176
  v_mul_f32 v185, v185, v176
  v_mul_f32 v186, v186, v176
  v_mul_f32 v187, v187, v176
  v_mul_f32 v188, v188, v176
  v_mul_f32 v189, v189, v176
  v_mul_f32 v190, v190, v176
  v_mul_f32 v191, v191, v176
  v_cvt_pk_bf16_f32 v64, v184, v185
  v_cvt_pk_bf16_f32 v65, v186, v187
  v_cvt_pk_bf16_f32 v66, v188, v189
  v_cvt_pk_bf16_f32 v67, v190, v191
  s_nop 1
  v_mfma_f32_16x16x32_bf16 v[16:19], a[192:195], v[64:67], 0
  v_mfma_f32_16x16x32_bf16 v[20:23], a[196:199], v[64:67], 0
  v_mfma_f32_16x16x32_bf16 v[24:27], a[200:203], v[64:67], 0
  v_mfma_f32_16x16x32_bf16 v[28:31], a[204:207], v[64:67], 0
  v_mfma_f32_16x16x32_bf16 v[32:35], a[208:211], v[64:67], 0
  v_mfma_f32_16x16x32_bf16 v[36:39], a[212:215], v[64:67], 0
  s_waitcnt vmcnt(5)
  v_dot2_f32_bf16 v184, v80, v168, 0
  v_dot2_f32_bf16 v185, v80, v169, 0
  v_dot2_f32_bf16 v186, v81, v168, 0
  v_dot2_f32_bf16 v187, v81, v169, 0
  v_dot2_f32_bf16 v188, v82, v168, 0
  v_dot2_f32_bf16 v189, v82, v169, 0
  v_dot2_f32_bf16 v190, v83, v168, 0
  v_dot2_f32_bf16 v191, v83, v169, 0
  buffer_load_dwordx4 v[144:147], v4, s[12:15], s68 offen offset:2048 sc1
  v_dot2_f32_bf16 v184, v84, v170, v184
  v_dot2_f32_bf16 v185, v84, v171, v185
  v_dot2_f32_bf16 v186, v85, v170, v186
  v_dot2_f32_bf16 v187, v85, v171, v187
  v_dot2_f32_bf16 v188, v86, v170, v188
  v_dot2_f32_bf16 v189, v86, v171, v189
  v_dot2_f32_bf16 v190, v87, v170, v190
  v_dot2_f32_bf16 v191, v87, v171, v191
  buffer_load_dwordx4 v[148:151], v4, s[12:15], s69 offen offset:2048 sc1
  v_dot2_f32_bf16 v184, v88, v172, v184
  v_dot2_f32_bf16 v185, v88, v173, v185
  v_dot2_f32_bf16 v186, v89, v172, v186
  v_dot2_f32_bf16 v187, v89, v173, v187
  v_dot2_f32_bf16 v188, v90, v172, v188
  v_dot2_f32_bf16 v189, v90, v173, v189
  v_dot2_f32_bf16 v190, v91, v172, v190
  v_dot2_f32_bf16 v191, v91, v173, v191
  buffer_load_dwordx4 v[152:155], v4, s[12:15], s70 offen offset:2048 sc1
  v_dot2_f32_bf16 v184, v92, v174, v184
  v_dot2_f32_bf16 v185, v92, v175, v185
  v_dot2_f32_bf16 v186, v93, v174, v186
  v_dot2_f32_bf16 v187, v93, v175, v187
  v_dot2_f32_bf16 v188, v94, v174, v188
  v_dot2_f32_bf16 v189, v94, v175, v189
  v_dot2_f32_bf16 v190, v95, v174, v190
  v_dot2_f32_bf16 v191, v95, v175, v191
  buffer_load_dwordx4 v[156:159], v4, s[12:15], s71 offen offset:2048 sc1
  s_nop 2
  v_mul_f32 v184, v184, v177
  v_mul_f32 v185, v185, v177
  v_mul_f32 v186, v186, v177
  v_mul_f32 v187, v187, v177
  v_mul_f32 v188, v188, v177
  v_mul_f32 v189, v189, v177
  v_mul_f32 v190, v190, v177
  v_mul_f32 v191, v191, v177
  v_cvt_pk_bf16_f32 v80, v184, v185
  v_cvt_pk_bf16_f32 v81, v186, v187
  v_cvt_pk_bf16_f32 v82, v188, v189
  v_cvt_pk_bf16_f32 v83, v190, v191
  s_nop 1
  v_mfma_f32_16x16x32_bf16 v[40:43], a[192:195], v[80:83], 0
  v_mfma_f32_16x16x32_bf16 v[44:47], a[196:199], v[80:83], 0
  v_mfma_f32_16x16x32_bf16 v[48:51], a[200:203], v[80:83], 0
  v_mfma_f32_16x16x32_bf16 v[52:55], a[204:207], v[80:83], 0
  v_mfma_f32_16x16x32_bf16 v[56:59], a[208:211], v[80:83], 0
  v_mfma_f32_16x16x32_bf16 v[60:63], a[212:215], v[80:83], 0
  buffer_load_dwordx4 v[200:203], v6, s[8:11], s47 offen
  buffer_load_dwordx4 v[204:207], v6, s[8:11], s49 offen
  buffer_load_dwordx4 v[208:211], v7, s[12:15], s26 offen sc1
  buffer_load_dwordx4 v[212:215], v7, s[12:15], s26 offen offset:16 sc1
  s_waitcnt vmcnt(20)
  v_dot2_f32_bf16 v184, v96, v160, 0
  v_dot2_f32_bf16 v185, v96, v161, 0
  v_dot2_f32_bf16 v186, v97, v160, 0
  v_dot2_f32_bf16 v187, v97, v161, 0
  v_dot2_f32_bf16 v188, v98, v160, 0
  v_dot2_f32_bf16 v189, v98, v161, 0
  v_dot2_f32_bf16 v190, v99, v160, 0
  v_dot2_f32_bf16 v191, v99, v161, 0
  s_add_u32 s72, s38, 8192
  buffer_load_dwordx4 a[96:99], v4, s[12:15], s72 offen offset:0 sc1
  v_dot2_f32_bf16 v184, v100, v162, v184
  v_dot2_f32_bf16 v185, v100, v163, v185
  v_dot2_f32_bf16 v186, v101, v162, v186
  v_dot2_f32_bf16 v187, v101, v163, v187
  v_dot2_f32_bf16 v188, v102, v162, v188
  v_dot2_f32_bf16 v189, v102, v163, v189
  v_dot2_f32_bf16 v190, v103, v162, v190
  v_dot2_f32_bf16 v191, v103, v163, v191
  buffer_load_dwordx4 a[108:111], v4, s[12:15], s72 offen offset:1024 sc1
  v_dot2_f32_bf16 v184, v104, v164, v184
  v_dot2_f32_bf16 v185, v104, v165, v185
  v_dot2_f32_bf16 v186, v105, v164, v186
  v_dot2_f32_bf16 v187, v105, v165, v187
  v_dot2_f32_bf16 v188, v106, v164, v188
  v_dot2_f32_bf16 v189, v106, v165, v189
  v_dot2_f32_bf16 v190, v107, v164, v190
  v_dot2_f32_bf16 v191, v107, v165, v191
  buffer_load_dwordx4 a[120:123], v4, s[12:15], s72 offen offset:2048 sc1
  v_dot2_f32_bf16 v184, v108, v166, v184
  v_dot2_f32_bf16 v185, v108, v167, v185
  v_dot2_f32_bf16 v186, v109, v166, v186
  v_dot2_f32_bf16 v187, v109, v167, v187
  v_dot2_f32_bf16 v188, v110, v166, v188
  v_dot2_f32_bf16 v189, v110, v167, v189
  v_dot2_f32_bf16 v190, v111, v166, v190
  v_dot2_f32_bf16 v191, v111, v167, v191
  buffer_load_dwordx4 a[132:135], v4, s[12:15], s72 offen offset:3072 sc1
  s_nop 2
  v_mul_f32 v184, v184, v176
  v_mul_f32 v185, v185, v176
  v_mul_f32 v186, v186, v176
  v_mul_f32 v187, v187, v176
  v_mul_f32 v188, v188, v176
  v_mul_f32 v189, v189, v176
  v_mul_f32 v190, v190, v176
  v_mul_f32 v191, v191, v176
  v_cvt_pk_bf16_f32 v96, v184, v185
  v_cvt_pk_bf16_f32 v97, v186, v187
  v_cvt_pk_bf16_f32 v98, v188, v189
  v_cvt_pk_bf16_f32 v99, v190, v191
  s_nop 1
  v_mfma_f32_16x16x32_bf16 v[16:19], a[216:219], v[96:99], v[16:19]
  v_mfma_f32_16x16x32_bf16 v[20:23], a[220:223], v[96:99], v[20:23]
  v_mfma_f32_16x16x32_bf16 v[24:27], a[224:227], v[96:99], v[24:27]
  v_mfma_f32_16x16x32_bf16 v[28:31], a[228:231], v[96:99], v[28:31]
  v_mfma_f32_16x16x32_bf16 v[32:35], a[232:235], v[96:99], v[32:35]
  v_mfma_f32_16x16x32_bf16 v[36:39], a[236:239], v[96:99], v[36:39]
  s_waitcnt vmcnt(16)
  v_dot2_f32_bf16 v184, v112, v168, 0
  v_dot2_f32_bf16 v185, v112, v169, 0
  v_dot2_f32_bf16 v186, v113, v168, 0
  v_dot2_f32_bf16 v187, v113, v169, 0
  v_dot2_f32_bf16 v188, v114, v168, 0
  v_dot2_f32_bf16 v189, v114, v169, 0
  v_dot2_f32_bf16 v190, v115, v168, 0
  v_dot2_f32_bf16 v191, v115, v169, 0
  s_add_u32 s73, s38, 20480
  buffer_load_dwordx4 a[100:103], v4, s[12:15], s73 offen offset:0 sc1
  v_dot2_f32_bf16 v184, v116, v170, v184
  v_dot2_f32_bf16 v185, v116, v171, v185
  v_dot2_f32_bf16 v186, v117, v170, v186
  v_dot2_f32_bf16 v187, v117, v171, v187
  v_dot2_f32_bf16 v188, v118, v170, v188
  v_dot2_f32_bf16 v189, v118, v171, v189
  v_dot2_f32_bf16 v190, v119, v170, v190
  v_dot2_f32_bf16 v191, v119, v171, v191
  buffer_load_dwordx4 a[112:115], v4, s[12:15], s73 offen offset:1024 sc1
  v_dot2_f32_bf16 v184, v120, v172, v184
  v_dot2_f32_bf16 v185, v120, v173, v185
  v_dot2_f32_bf16 v186, v121, v172, v186
  v_dot2_f32_bf16 v187, v121, v173, v187
  v_dot2_f32_bf16 v188, v122, v172, v188
  v_dot2_f32_bf16 v189, v122, v173, v189
  v_dot2_f32_bf16 v190, v123, v172, v190
  v_dot2_f32_bf16 v191, v123, v173, v191
  buffer_load_dwordx4 a[124:127], v4, s[12:15], s73 offen offset:2048 sc1
  v_dot2_f32_bf16 v184, v124, v174, v184
  v_dot2_f32_bf16 v185, v124, v175, v185
  v_dot2_f32_bf16 v186, v125, v174, v186
  v_dot2_f32_bf16 v187, v125, v175, v187
  v_dot2_f32_bf16 v188, v126, v174, v188
  v_dot2_f32_bf16 v189, v126, v175, v189
  v_dot2_f32_bf16 v190, v127, v174, v190
  v_dot2_f32_bf16 v191, v127, v175, v191
  buffer_load_dwordx4 a[136:139], v4, s[12:15], s73 offen offset:3072 sc1
  s_nop 2
  v_mul_f32 v184, v184, v177
  v_mul_f32 v185, v185, v177
  v_mul_f32 v186, v186, v177
  v_mul_f32 v187, v187, v177
  v_mul_f32 v188, v188, v177
  v_mul_f32 v189, v189, v177
  v_mul_f32 v190, v190, v177
  v_mul_f32 v191, v191, v177
  v_cvt_pk_bf16_f32 v112, v184, v185
  v_cvt_pk_bf16_f32 v113, v186, v187
  v_cvt_pk_bf16_f32 v114, v188, v189
  v_cvt_pk_bf16_f32 v115, v190, v191
  s_nop 1
  v_mfma_f32_16x16x32_bf16 v[40:43], a[216:219], v[112:115], v[40:43]
  v_mfma_f32_16x16x32_bf16 v[44:47], a[220:223], v[112:115], v[44:47]
  v_mfma_f32_16x16x32_bf16 v[48:51], a[224:227], v[112:115], v[48:51]
  v_mfma_f32_16x16x32_bf16 v[52:55], a[228:231], v[112:115], v[52:55]
  v_mfma_f32_16x16x32_bf16 v[56:59], a[232:235], v[112:115], v[56:59]
  v_mfma_f32_16x16x32_bf16 v[60:63], a[236:239], v[112:115], v[60:63]
  s_waitcnt vmcnt(16)
  v_dot2_f32_bf16 v184, v128, v160, 0
  v_dot2_f32_bf16 v185, v128, v161, 0
  v_dot2_f32_bf16 v186, v129, v160, 0
  v_dot2_f32_bf16 v187, v129, v161, 0
  v_dot2_f32_bf16 v188, v130, v160, 0
  v_dot2_f32_bf16 v189, v130, v161, 0
  v_dot2_f32_bf16 v190, v131, v160, 0
  v_dot2_f32_bf16 v191, v131, v161, 0
  s_add_u32 s74, s38, 32768
  buffer_load_dwordx4 a[104:107], v4, s[12:15], s74 offen offset:0 sc1
  v_dot2_f32_bf16 v184, v132, v162, v184
  v_dot2_f32_bf16 v185, v132, v163, v185
  v_dot2_f32_bf16 v186, v133, v162, v186
  v_dot2_f32_bf16 v187, v133, v163, v187
  v_dot2_f32_bf16 v188, v134, v162, v188
  v_dot2_f32_bf16 v189, v134, v163, v189
  v_dot2_f32_bf16 v190, v135, v162, v190
  v_dot2_f32_bf16 v191, v135, v163, v191
  buffer_load_dwordx4 a[116:119], v4, s[12:15], s74 offen offset:1024 sc1
  v_dot2_f32_bf16 v184, v136, v164, v184
  v_dot2_f32_bf16 v185, v136, v165, v185
  v_dot2_f32_bf16 v186, v137, v164, v186
  v_dot2_f32_bf16 v187, v137, v165, v187
  v_dot2_f32_bf16 v188, v138, v164, v188
  v_dot2_f32_bf16 v189, v138, v165, v189
  v_dot2_f32_bf16 v190, v139, v164, v190
  v_dot2_f32_bf16 v191, v139, v165, v191
  buffer_load_dwordx4 a[128:131], v4, s[12:15], s74 offen offset:2048 sc1
  v_dot2_f32_bf16 v184, v140, v166, v184
  v_dot2_f32_bf16 v185, v140, v167, v185
  v_dot2_f32_bf16 v186, v141, v166, v186
  v_dot2_f32_bf16 v187, v141, v167, v187
  v_dot2_f32_bf16 v188, v142, v166, v188
  v_dot2_f32_bf16 v189, v142, v167, v189
  v_dot2_f32_bf16 v190, v143, v166, v190
  v_dot2_f32_bf16 v191, v143, v167, v191
  buffer_load_dwordx4 a[140:143], v4, s[12:15], s74 offen offset:3072 sc1
  s_nop 2
  v_mul_f32 v184, v184, v176
  v_mul_f32 v185, v185, v176
  v_mul_f32 v186, v186, v176
  v_mul_f32 v187, v187, v176
  v_mul_f32 v188, v188, v176
  v_mul_f32 v189, v189, v176
  v_mul_f32 v190, v190, v176
  v_mul_f32 v191, v191, v176
  v_cvt_pk_bf16_f32 v128, v184, v185
  v_cvt_pk_bf16_f32 v129, v186, v187
  v_cvt_pk_bf16_f32 v130, v188, v189
  v_cvt_pk_bf16_f32 v131, v190, v191
  s_nop 1
  v_mfma_f32_16x16x32_bf16 v[16:19], a[240:243], v[128:131], v[16:19]
  v_mfma_f32_16x16x32_bf16 v[20:23], a[244:247], v[128:131], v[20:23]
  v_mfma_f32_16x16x32_bf16 v[24:27], a[248:251], v[128:131], v[24:27]
  v_mfma_f32_16x16x32_bf16 v[28:31], a[252:255], v[128:131], v[28:31]
  v_mfma_f32_16x16x32_bf16 v[32:35], v[248:251], v[128:131], v[32:35]
  v_mfma_f32_16x16x32_bf16 v[36:39], v[252:255], v[128:131], v[36:39]
  s_waitcnt vmcnt(16)
  v_dot2_f32_bf16 v184, v144, v168, 0
  v_dot2_f32_bf16 v185, v144, v169, 0
  v_dot2_f32_bf16 v186, v145, v168, 0
  v_dot2_f32_bf16 v187, v145, v169, 0
  v_dot2_f32_bf16 v188, v146, v168, 0
  v_dot2_f32_bf16 v189, v146, v169, 0
  v_dot2_f32_bf16 v190, v147, v168, 0
  v_dot2_f32_bf16 v191, v147, v169, 0
  v_dot2_f32_bf16 v184, v148, v170, v184
  v_dot2_f32_bf16 v185, v148, v171, v185
  v_dot2_f32_bf16 v186, v149, v170, v186
  v_dot2_f32_bf16 v187, v149, v171, v187
  v_dot2_f32_bf16 v188, v150, v170, v188
  v_dot2_f32_bf16 v189, v150, v171, v189
  v_dot2_f32_bf16 v190, v151, v170, v190
  v_dot2_f32_bf16 v191, v151, v171, v191
  v_dot2_f32_bf16 v184, v152, v172, v184
  v_dot2_f32_bf16 v185, v152, v173, v185
  v_dot2_f32_bf16 v186, v153, v172, v186
  v_dot2_f32_bf16 v187, v153, v173, v187
  v_dot2_f32_bf16 v188, v154, v172, v188
  v_dot2_f32_bf16 v189, v154, v173, v189
  v_dot2_f32_bf16 v190, v155, v172, v190
  v_dot2_f32_bf16 v191, v155, v173, v191
  v_dot2_f32_bf16 v184, v156, v174, v184
  v_dot2_f32_bf16 v185, v156, v175, v185
  v_dot2_f32_bf16 v186, v157, v174, v186
  v_dot2_f32_bf16 v187, v157, v175, v187
  v_dot2_f32_bf16 v188, v158, v174, v188
  v_dot2_f32_bf16 v189, v158, v175, v189
  v_dot2_f32_bf16 v190, v159, v174, v190
  v_dot2_f32_bf16 v191, v159, v175, v191
  s_nop 2
  v_mul_f32 v184, v184, v177
  v_mul_f32 v185, v185, v177
  v_mul_f32 v186, v186, v177
  v_mul_f32 v187, v187, v177
  v_mul_f32 v188, v188, v177
  v_mul_f32 v189, v189, v177
  v_mul_f32 v190, v190, v177
  v_mul_f32 v191, v191, v177
  v_cvt_pk_bf16_f32 v144, v184, v185
  v_cvt_pk_bf16_f32 v145, v186, v187
  v_cvt_pk_bf16_f32 v146, v188, v189
  v_cvt_pk_bf16_f32 v147, v190, v191
  s_nop 1
  v_mfma_f32_16x16x32_bf16 v[40:43], a[240:243], v[144:147], v[40:43]
  v_mfma_f32_16x16x32_bf16 v[44:47], a[244:247], v[144:147], v[44:47]
  v_mfma_f32_16x16x32_bf16 v[48:51], a[248:251], v[144:147], v[48:51]
  v_mfma_f32_16x16x32_bf16 v[52:55], a[252:255], v[144:147], v[52:55]
  v_mfma_f32_16x16x32_bf16 v[56:59], v[248:251], v[144:147], v[56:59]
  v_mfma_f32_16x16x32_bf16 v[60:63], v[252:255], v[144:147], v[60:63]
  s_waitcnt vmcnt(12)
  s_mul_i32 s50, s3, 12288
  v_add_u32 v8, s50, v4
  s_lshl_b32 s50, s41, 11
  v_lshrrev_b32 v9, 1, v3
  v_lshlrev_b32 v9, 10, v9
  v_and_b32 v13, 1, v3
  v_lshl_add_u32 v9, v13, 9, v9
  v_lshl_add_u32 v9, v2, 4, v9
  v_add_u32 v9, s50, v9
  ds_write_b128 v8, v[16:19] offset:0
  ds_write_b128 v8, v[20:23] offset:1024
  ds_write_b128 v8, v[24:27] offset:2048
  ds_write_b128 v8, v[28:31] offset:3072
  ds_write_b128 v8, v[32:35] offset:4096
  ds_write_b128 v8, v[36:39] offset:5120
  ds_write_b128 v8, v[40:43] offset:6144
  ds_write_b128 v8, v[44:47] offset:7168
  ds_write_b128 v8, v[48:51] offset:8192
  ds_write_b128 v8, v[52:55] offset:9216
  ds_write_b128 v8, v[56:59] offset:10240
  ds_write_b128 v8, v[60:63] offset:11264
  s_waitcnt lgkmcnt(0)
  s_barrier
  s_cmp_eq_u32 s3, 3
  s_cbranch_scc1 mega_kernel_wo3
  ds_read_b128 v[64:67], v9 offset:0
  ds_read_b128 v[68:71], v9 offset:256
  ds_read_b128 v[72:75], v9 offset:12288
  ds_read_b128 v[76:79], v9 offset:12544
  ds_read_b128 v[80:83], v9 offset:24576
  ds_read_b128 v[84:87], v9 offset:24832
  ds_read_b128 v[88:91], v9 offset:36864
  ds_read_b128 v[92:95], v9 offset:37120
  ds_read_b128 v[96:99], v9 offset:6144
  ds_read_b128 v[100:103], v9 offset:6400
  ds_read_b128 v[104:107], v9 offset:18432
  ds_read_b128 v[108:111], v9 offset:18688
  ds_read_b128 v[112:115], v9 offset:30720
  ds_read_b128 v[116:119], v9 offset:30976
  ds_read_b128 v[120:123], v9 offset:43008
  ds_read_b128 v[124:127], v9 offset:43264
  v_lshlrev_b32 v128, 16, v200
  v_and_b32 v129, 0xffff0000, v200
  v_lshlrev_b32 v130, 16, v201
  v_and_b32 v131, 0xffff0000, v201
  v_lshlrev_b32 v132, 16, v202
  v_and_b32 v133, 0xffff0000, v202
  v_lshlrev_b32 v134, 16, v203
  v_and_b32 v135, 0xffff0000, v203
  s_waitcnt lgkmcnt(8)
  v_add_f32 v64, v64, v72
  v_add_f32 v80, v80, v88
  v_add_f32 v65, v65, v73
  v_add_f32 v81, v81, v89
  v_add_f32 v66, v66, v74
  v_add_f32 v82, v82, v90
  v_add_f32 v67, v67, v75
  v_add_f32 v83, v83, v91
  v_add_f32 v68, v68, v76
  v_add_f32 v84, v84, v92
  v_add_f32 v69, v69, v77
  v_add_f32 v85, v85, v93
  v_add_f32 v70, v70, v78
  v_add_f32 v86, v86, v94
  v_add_f32 v71, v71, v79
  v_add_f32 v87, v87, v95
  v_add_f32 v64, v64, v80
  v_add_f32 v65, v65, v81
  v_add_f32 v66, v66, v82
  v_add_f32 v67, v67, v83
  v_add_f32 v68, v68, v84
  v_add_f32 v69, v69, v85
  v_add_f32 v70, v70, v86
  v_add_f32 v71, v71, v87
  v_fma_f32 v64, v64, v208, v128
  v_fma_f32 v65, v65, v209, v129
  v_fma_f32 v66, v66, v210, v130
  v_fma_f32 v67, v67, v211, v131
  v_fma_f32 v68, v68, v212, v132
  v_fma_f32 v69, v69, v213, v133
  v_fma_f32 v70, v70, v214, v134
  v_fma_f32 v71, v71, v215, v135
  v_cvt_pk_bf16_f32 v64, v64, v65
  v_cvt_pk_bf16_f32 v65, v66, v67
  v_cvt_pk_bf16_f32 v66, v68, v69
  v_cvt_pk_bf16_f32 v67, v70, v71
  s_cmp_eq_u32 s63, 1
  s_cbranch_scc1 mega_kernel_dfx0
  buffer_store_dwordx4 v[64:67], v4, s[12:15], s25 offen sc1
  s_branch mega_kernel_dex0
mega_kernel_dfx0:
  buffer_store_dwordx4 v[64:67], v4, s[12:15], s25 offen
mega_kernel_dex0:
  v_lshlrev_b32 v128, 16, v204
  v_and_b32 v129, 0xffff0000, v204
  v_lshlrev_b32 v130, 16, v205
  v_and_b32 v131, 0xffff0000, v205
  v_lshlrev_b32 v132, 16, v206
  v_and_b32 v133, 0xffff0000, v206
  v_lshlrev_b32 v134, 16, v207
  v_and_b32 v135, 0xffff0000, v207
  s_waitcnt lgkmcnt(0)
  v_add_f32 v96, v96, v104
  v_add_f32 v112, v112, v120
  v_add_f32 v97, v97, v105
  v_add_f32 v113, v113, v121
  v_add_f32 v98, v98, v106
  v_add_f32 v114, v114, v122
  v_add_f32 v99, v99, v107
  v_add_f32 v115, v115, v123
  v_add_f32 v100, v100, v108
  v_add_f32 v116, v116, v124
  v_add_f32 v101, v101, v109
  v_add_f32 v117, v117, v125
  v_add_f32 v102, v102, v110
  v_add_f32 v118, v118, v126
  v_add_f32 v103, v103, v111
  v_add_f32 v119, v119, v127
  v_add_f32 v96, v96, v112
  v_add_f32 v97, v97, v113
  v_add_f32 v98, v98, v114
  v_add_f32 v99, v99, v115
  v_add_f32 v100, v100, v116
  v_add_f32 v101, v101, v117
  v_add_f32 v102, v102, v118
  v_add_f32 v103, v103, v119
  v_fma_f32 v96, v96, v208, v128
  v_fma_f32 v97, v97, v209, v129
  v_fma_f32 v98, v98, v210, v130
  v_fma_f32 v99, v99, v211, v131
  v_fma_f32 v100, v100, v212, v132
  v_fma_f32 v101, v101, v213, v133
  v_fma_f32 v102, v102, v214, v134
  v_fma_f32 v103, v103, v215, v135
  v_cvt_pk_bf16_f32 v96, v96, v97
  v_cvt_pk_bf16_f32 v97, v98, v99
  v_cvt_pk_bf16_f32 v98, v100, v101
  v_cvt_pk_bf16_f32 v99, v102, v103
  s_cmp_eq_u32 s63, 1
  s_cbranch_scc1 mega_kernel_dfx1
  buffer_store_dwordx4 v[96:99], v4, s[12:15], s31 offen sc1
  s_branch mega_kernel_dex1
mega_kernel_dfx1:
  buffer_store_dwordx4 v[96:99], v4, s[12:15], s31 offen
mega_kernel_dex1:
mega_kernel_wo3:
  s_and_b32 s44, s36, 1
  s_lshl_b32 s44, s44, 2
  s_add_u32 s44, s44, s37
  s_lshl_b32 s56, s30, 7
  s_lshl_b32 s57, s44, 2
  s_add_u32 s56, s56, s57
  s_add_u32 s56, s56, 40960
  v_mov_b32 v10, 0
  v_mov_b32 v11, 1
  s_cmp_lg_u32 s3, 0
  s_waitcnt vmcnt(0)
  s_barrier
  s_cbranch_scc1 mega_kernel_pubw
  s_mov_b64 exec, 1
  s_cmp_eq_u32 s63, 1
  s_cbranch_scc1 mega_kernel_dfpw
  buffer_store_dword v11, v10, s[12:15], s56 offen sc1
  s_branch mega_kernel_depw
mega_kernel_dfpw:
  buffer_store_dword v11, v10, s[12:15], s56 offen
mega_kernel_depw:
  s_mov_b64 exec, -1
mega_kernel_pubw:
  s_mul_i32 s46, s20, 49152
  s_add_u32 s46, s46, 2752512
  s_lshr_b32 s47, s20, 4
  s_mul_i32 s48, s47, 9216
  s_add_u32 s48, s48, 4608
  s_mul_i32 s29, s20, 196608
  s_mul_i32 s30, s21, 6144
  s_add_u32 s30, s29, s30
  s_add_u32 s30, s30, 9175040
  v_lshlrev_b32 v7, 5, v3
  v_add_u32 v7, 92160, v7
  s_mul_i32 s50, s3, 12288
  v_add_u32 v8, s50, v4
  s_add_u32 s50, s50, s46
  s_lshr_b32 s56, s3, 1
  s_mul_i32 s56, s56, 393216
  s_and_b32 s57, s3, 1
  s_mul_i32 s57, s57, 12288
  s_add_u32 s56, s56, s57
  s_add_u32 s34, s34, s56
  s_mov_b32 s50, s34
  s_add_u32 s51, s50, 4096
  s_add_u32 s52, s50, 8192
  v_and_b32 v10, 3, v1
  s_lshr_b32 s57, s3, 1
  s_lshl_b32 s57, s57, 4
  v_lshlrev_b32 v10, 2, v10
  s_lshl_b32 s58, s20, 7
  s_add_u32 s58, s58, s57
  v_add_u32 v10, s58, v10
  s_mov_b32 s56, 40960
  s_mov_b32 s57, 0x100000
mega_kernel_plf:
  buffer_load_dword v11, v10, s[12:15], s56 offen sc1
  s_waitcnt vmcnt(0)
  v_cmp_ne_u32 vcc, 1, v11
  s_sub_u32 s57, s57, 1
  s_cbranch_scc1 mega_kernel_pdf
  s_cbranch_vccz mega_kernel_pdf
  s_sleep 1
  s_branch mega_kernel_plf
mega_kernel_pdf:
  buffer_load_dwordx4 v[16:19], v4, s[12:15], s50 offen offset:0 sc1
  buffer_load_dwordx4 v[20:23], v4, s[12:15], s50 offen offset:1024 sc1
  buffer_load_dwordx4 v[24:27], v4, s[12:15], s50 offen offset:2048 sc1
  buffer_load_dwordx4 v[28:31], v4, s[12:15], s50 offen offset:3072 sc1
  buffer_load_dwordx4 v[32:35], v4, s[12:15], s51 offen offset:0 sc1
  buffer_load_dwordx4 v[36:39], v4, s[12:15], s51 offen offset:1024 sc1
  buffer_load_dwordx4 v[40:43], v4, s[12:15], s51 offen offset:2048 sc1
  buffer_load_dwordx4 v[44:47], v4, s[12:15], s51 offen offset:3072 sc1
  buffer_load_dwordx4 v[48:51], v4, s[12:15], s52 offen offset:0 sc1
  buffer_load_dwordx4 v[52:55], v4, s[12:15], s52 offen offset:1024 sc1
  buffer_load_dwordx4 v[56:59], v4, s[12:15], s52 offen offset:2048 sc1
  buffer_load_dwordx4 v[60:63], v4, s[12:15], s52 offen offset:3072 sc1
  v_lshlrev_b32 v9, 4, v3
  v_add_u32 v9, 95232, v9
  ds_read_b128 a[144:147], v9 offset:0
  ds_read_b128 a[148:151], v9 offset:64
  ds_read_b128 a[152:155], v9 offset:128
  ds_read_b128 a[156:159], v9 offset:192
  ds_read_b128 a[160:163], v9 offset:256
  ds_read_b128 a[164:167], v9 offset:320
  ds_read_b128 a[168:171], v9 offset:384
  ds_read_b128 a[172:175], v9 offset:448
  ds_read_b128 a[176:179], v9 offset:512
  ds_read_b128 a[180:183], v9 offset:576
  ds_read_b128 a[184:187], v9 offset:640
  ds_read_b128 a[188:191], v9 offset:704
  ds_read_b128 v[112:115], v7 offset:1536
  ds_read_b128 v[116:119], v7 offset:1552
  ds_read_b128 v[120:123], v7 offset:1664
  ds_read_b128 v[124:127], v7 offset:1680
  ds_read_b128 v[128:131], v7 offset:1792
  ds_read_b128 v[132:135], v7 offset:1808
  ds_read_b128 v[136:139], v7 offset:1920
  ds_read_b128 v[140:143], v7 offset:1936
  ds_read_b128 v[144:147], v7 offset:2048
  ds_read_b128 v[148:151], v7 offset:2064
  ds_read_b128 v[152:155], v7 offset:2176
  ds_read_b128 v[156:159], v7 offset:2192
  ds_read_b128 v[160:163], v7 offset:2304
  ds_read_b128 v[164:167], v7 offset:2320
  ds_read_b128 v[168:171], v7 offset:2432
  ds_read_b128 v[172:175], v7 offset:2448
  ds_read_b128 v[176:179], v7 offset:2560
  ds_read_b128 v[180:183], v7 offset:2576
  ds_read_b128 v[184:187], v7 offset:2688
  ds_read_b128 v[188:191], v7 offset:2704
  ds_read_b128 v[192:195], v7 offset:2816
  ds_read_b128 v[196:199], v7 offset:2832
  ds_read_b128 v[200:203], v7 offset:2944
  ds_read_b128 v[204:207], v7 offset:2960
  s_mul_i32 s56, s3, 3
  s_add_u32 s57, s56, 0
  s_lshr_b32 s58, s57, 1
  s_lshl_b32 s58, s58, 10
  s_and_b32 s57, s57, 1
  s_lshl_b32 s57, s57, 3
  s_add_u32 s58, s58, s57
  s_add_u32 s58, s58, 65536
  v_add_u32 v12, s58, v4
  s_add_u32 s57, s56, 1
  s_lshr_b32 s58, s57, 1
  s_lshl_b32 s58, s58, 10
  s_and_b32 s57, s57, 1
  s_lshl_b32 s57, s57, 3
  s_add_u32 s58, s58, s57
  s_add_u32 s58, s58, 65536
  v_add_u32 v13, s58, v4
  s_add_u32 s57, s56, 2
  s_lshr_b32 s58, s57, 1
  s_lshl_b32 s58, s58, 10
  s_and_b32 s57, s57, 1
  s_lshl_b32 s57, s57, 3
  s_add_u32 s58, s58, s57
  s_add_u32 s58, s58, 65536
  v_add_u32 v14, s58, v4
  s_mul_i32 s58, s3, 6144
  s_add_u32 s58, s58, 65536
  v_add_u32 v15, s58, v4
  s_mov_b32 s55, 0x3f803f80
  v_mov_b32 v5, 0x3f80
  v_mov_b32 v6, 0x3f800000
  s_lshl_b32 s56, s3, 6
  s_add_u32 s56, s56, 53248
  v_lshlrev_b32 v9, 2, v2
  v_add_u32 v7, s56, v9
  v_add_u32 v9, 53248, v9
  v_mov_b32 v64, 0
  v_mov_b32 v65, 0
  v_mov_b32 v66, 0
  v_mov_b32 v67, 0
  v_mov_b32 v68, 0
  v_mov_b32 v69, 0
  v_mov_b32 v70, 0
  v_mov_b32 v71, 0
  s_waitcnt lgkmcnt(0)
  s_waitcnt vmcnt(10)
  v_dot2c_f32_bf16 v64, s55, v16
  v_dot2c_f32_bf16 v68, v16, v16
  v_dot2c_f32_bf16 v65, s55, v17
  v_dot2c_f32_bf16 v69, v17, v17
  v_dot2c_f32_bf16 v66, s55, v18
  v_dot2c_f32_bf16 v70, v18, v18
  v_dot2c_f32_bf16 v67, s55, v19
  v_dot2c_f32_bf16 v71, v19, v19
  v_dot2c_f32_bf16 v64, s55, v20
  v_dot2c_f32_bf16 v68, v20, v20
  v_dot2c_f32_bf16 v65, s55, v21
  v_dot2c_f32_bf16 v69, v21, v21
  v_dot2c_f32_bf16 v66, s55, v22
  v_dot2c_f32_bf16 v70, v22, v22
  v_dot2c_f32_bf16 v67, s55, v23
  v_dot2c_f32_bf16 v71, v23, v23
  s_waitcnt vmcnt(8)
  v_dot2c_f32_bf16 v64, s55, v24
  v_dot2c_f32_bf16 v68, v24, v24
  v_dot2c_f32_bf16 v65, s55, v25
  v_dot2c_f32_bf16 v69, v25, v25
  v_dot2c_f32_bf16 v66, s55, v26
  v_dot2c_f32_bf16 v70, v26, v26
  v_dot2c_f32_bf16 v67, s55, v27
  v_dot2c_f32_bf16 v71, v27, v27
  v_dot2c_f32_bf16 v64, s55, v28
  v_dot2c_f32_bf16 v68, v28, v28
  v_dot2c_f32_bf16 v65, s55, v29
  v_dot2c_f32_bf16 v69, v29, v29
  v_dot2c_f32_bf16 v66, s55, v30
  v_dot2c_f32_bf16 v70, v30, v30
  v_dot2c_f32_bf16 v67, s55, v31
  v_dot2c_f32_bf16 v71, v31, v31
  s_waitcnt vmcnt(6)
  v_dot2c_f32_bf16 v64, s55, v32
  v_dot2c_f32_bf16 v68, v32, v32
  v_dot2c_f32_bf16 v65, s55, v33
  v_dot2c_f32_bf16 v69, v33, v33
  v_dot2c_f32_bf16 v66, s55, v34
  v_dot2c_f32_bf16 v70, v34, v34
  v_dot2c_f32_bf16 v67, s55, v35
  v_dot2c_f32_bf16 v71, v35, v35
  v_dot2c_f32_bf16 v64, s55, v36
  v_dot2c_f32_bf16 v68, v36, v36
  v_dot2c_f32_bf16 v65, s55, v37
  v_dot2c_f32_bf16 v69, v37, v37
  v_dot2c_f32_bf16 v66, s55, v38
  v_dot2c_f32_bf16 v70, v38, v38
  v_dot2c_f32_bf16 v67, s55, v39
  v_dot2c_f32_bf16 v71, v39, v39
  s_waitcnt vmcnt(4)
  v_dot2c_f32_bf16 v64, s55, v40
  v_dot2c_f32_bf16 v68, v40, v40
  v_dot2c_f32_bf16 v65, s55, v41
  v_dot2c_f32_bf16 v69, v41, v41
  v_dot2c_f32_bf16 v66, s55, v42
  v_dot2c_f32_bf16 v70, v42, v42
  v_dot2c_f32_bf16 v67, s55, v43
  v_dot2c_f32_bf16 v71, v43, v43
  v_dot2c_f32_bf16 v64, s55, v44
  v_dot2c_f32_bf16 v68, v44, v44
  v_dot2c_f32_bf16 v65, s55, v45
  v_dot2c_f32_bf16 v69, v45, v45
  v_dot2c_f32_bf16 v66, s55, v46
  v_dot2c_f32_bf16 v70, v46, v46
  v_dot2c_f32_bf16 v67, s55, v47
  v_dot2c_f32_bf16 v71, v47, v47
  s_waitcnt vmcnt(2)
  v_dot2c_f32_bf16 v64, s55, v48
  v_dot2c_f32_bf16 v68, v48, v48
  v_dot2c_f32_bf16 v65, s55, v49
  v_dot2c_f32_bf16 v69, v49, v49
  v_dot2c_f32_bf16 v66, s55, v50
  v_dot2c_f32_bf16 v70, v50, v50
  v_dot2c_f32_bf16 v67, s55, v51
  v_dot2c_f32_bf16 v71, v51, v51
  v_dot2c_f32_bf16 v64, s55, v52
  v_dot2c_f32_bf16 v68, v52, v52
  v_dot2c_f32_bf16 v65, s55, v53
  v_dot2c_f32_bf16 v69, v53, v53
  v_dot2c_f32_bf16 v66, s55, v54
  v_dot2c_f32_bf16 v70, v54, v54
  v_dot2c_f32_bf16 v67, s55, v55
  v_dot2c_f32_bf16 v71, v55, v55
  s_waitcnt vmcnt(0)
  v_dot2c_f32_bf16 v64, s55, v56
  v_dot2c_f32_bf16 v68, v56, v56
  v_dot2c_f32_bf16 v65, s55, v57
  v_dot2c_f32_bf16 v69, v57, v57
  v_dot2c_f32_bf16 v66, s55, v58
  v_dot2c_f32_bf16 v70, v58, v58
  v_dot2c_f32_bf16 v67, s55, v59
  v_dot2c_f32_bf16 v71, v59, v59
  v_dot2c_f32_bf16 v64, s55, v60
  v_dot2c_f32_bf16 v68, v60, v60
  v_dot2c_f32_bf16 v65, s55, v61
  v_dot2c_f32_bf16 v69, v61, v61
  v_dot2c_f32_bf16 v66, s55, v62
  v_dot2c_f32_bf16 v70, v62, v62
  v_dot2c_f32_bf16 v67, s55, v63
  v_dot2c_f32_bf16 v71, v63, v63
  s_nop 2
  v_add_f32 v64, v64, v65
  v_add_f32 v66, v66, v67
  v_add_f32 v68, v68, v69
  v_add_f32 v70, v70, v71
  v_add_f32 v64, v64, v66
  v_add_f32 v65, v68, v70
  v_mov_b32 v66, v64
  v_mov_b32 v67, v65
  s_nop 1
  v_permlane16_swap_b32 v64, v66
  v_permlane16_swap_b32 v65, v67
  s_nop 1
  v_add_f32 v64, v64, v66
  v_add_f32 v65, v65, v67
  v_mov_b32 v66, v64
  v_mov_b32 v67, v65
  s_nop 1
  v_permlane32_swap_b32 v64, v66
  v_permlane32_swap_b32 v65, v67
  s_nop 1
  v_add_f32 v64, v64, v66
  v_add_f32 v65, v65, v67
  v_mul_f32 v64, 0xbb2aaaab, v64
  v_mul_f32 v65, 0x3b2aaaab, v65
  v_fma_f32 v65, -v64, v64, v65
  v_max_f32 v65, 0, v65
  v_add_f32 v65, 0x3727c5ac, v65
  v_rsq_f32 v66, v65
  v_dot2_f32_bf16 v72, v16, v5, v64
  v_dot2_f32_bf16 v73, v16, v6, v64
  v_dot2_f32_bf16 v74, v17, v5, v64
  v_dot2_f32_bf16 v75, v17, v6, v64
  v_dot2_f32_bf16 v76, v18, v5, v64
  v_dot2_f32_bf16 v77, v18, v6, v64
  v_dot2_f32_bf16 v78, v19, v5, v64
  v_dot2_f32_bf16 v79, v19, v6, v64
  ds_write_b32 v7, v66
  v_dot2_f32_bf16 v80, v20, v5, v64
  v_dot2_f32_bf16 v81, v20, v6, v64
  v_dot2_f32_bf16 v82, v21, v5, v64
  v_dot2_f32_bf16 v83, v21, v6, v64
  v_dot2_f32_bf16 v84, v22, v5, v64
  v_dot2_f32_bf16 v85, v22, v6, v64
  v_dot2_f32_bf16 v86, v23, v5, v64
  v_dot2_f32_bf16 v87, v23, v6, v64
  v_mfma_f32_16x16x32_bf16 v[208:211], a[0:3], a[144:147], 0
  v_mul_f32 v72, v72, v112
  v_mul_f32 v73, v73, v113
  v_mul_f32 v74, v74, v114
  v_mul_f32 v75, v75, v115
  v_mul_f32 v76, v76, v116
  v_mul_f32 v77, v77, v117
  v_mul_f32 v78, v78, v118
  v_mul_f32 v79, v79, v119
  v_mfma_f32_16x16x32_bf16 v[212:215], a[4:7], a[144:147], 0
  v_cvt_pk_bf16_f32 v16, v72, v73
  v_cvt_pk_bf16_f32 v17, v74, v75
  v_cvt_pk_bf16_f32 v18, v76, v77
  v_cvt_pk_bf16_f32 v19, v78, v79
  v_mfma_f32_16x16x32_bf16 v[216:219], a[8:11], a[144:147], 0
  ds_write_b128 v8, v[16:19] offset:0
  v_dot2_f32_bf16 v72, v24, v5, v64
  v_dot2_f32_bf16 v73, v24, v6, v64
  v_dot2_f32_bf16 v74, v25, v5, v64
  v_dot2_f32_bf16 v75, v25, v6, v64
  v_dot2_f32_bf16 v76, v26, v5, v64
  v_dot2_f32_bf16 v77, v26, v6, v64
  v_dot2_f32_bf16 v78, v27, v5, v64
  v_dot2_f32_bf16 v79, v27, v6, v64
  v_mfma_f32_16x16x32_bf16 v[208:211], a[12:15], a[148:151], v[208:211]
  v_mul_f32 v80, v80, v120
  v_mul_f32 v81, v81, v121
  v_mul_f32 v82, v82, v122
  v_mul_f32 v83, v83, v123
  v_mul_f32 v84, v84, v124
  v_mul_f32 v85, v85, v125
  v_mul_f32 v86, v86, v126
  v_mul_f32 v87, v87, v127
  v_mfma_f32_16x16x32_bf16 v[212:215], a[16:19], a[148:151], v[212:215]
  v_cvt_pk_bf16_f32 v20, v80, v81
  v_cvt_pk_bf16_f32 v21, v82, v83
  v_cvt_pk_bf16_f32 v22, v84, v85
  v_cvt_pk_bf16_f32 v23, v86, v87
  v_mfma_f32_16x16x32_bf16 v[216:219], a[20:23], a[148:151], v[216:219]
  ds_write_b128 v8, v[20:23] offset:1024
  v_dot2_f32_bf16 v80, v28, v5, v64
  v_dot2_f32_bf16 v81, v28, v6, v64
  v_dot2_f32_bf16 v82, v29, v5, v64
  v_dot2_f32_bf16 v83, v29, v6, v64
  v_dot2_f32_bf16 v84, v30, v5, v64
  v_dot2_f32_bf16 v85, v30, v6, v64
  v_dot2_f32_bf16 v86, v31, v5, v64
  v_dot2_f32_bf16 v87, v31, v6, v64
  v_mfma_f32_16x16x32_bf16 v[208:211], a[24:27], a[152:155], v[208:211]
  v_mul_f32 v72, v72, v128
  v_mul_f32 v73, v73, v129
  v_mul_f32 v74, v74, v130
  v_mul_f32 v75, v75, v131
  v_mul_f32 v76, v76, v132
  v_mul_f32 v77, v77, v133
  v_mul_f32 v78, v78, v134
  v_mul_f32 v79, v79, v135
  v_mfma_f32_16x16x32_bf16 v[212:215], a[28:31], a[152:155], v[212:215]
  v_cvt_pk_bf16_f32 v24, v72, v73
  v_cvt_pk_bf16_f32 v25, v74, v75
  v_cvt_pk_bf16_f32 v26, v76, v77
  v_cvt_pk_bf16_f32 v27, v78, v79
  v_mfma_f32_16x16x32_bf16 v[216:219], a[32:35], a[152:155], v[216:219]
  ds_write_b128 v8, v[24:27] offset:2048
  v_dot2_f32_bf16 v72, v32, v5, v64
  v_dot2_f32_bf16 v73, v32, v6, v64
  v_dot2_f32_bf16 v74, v33, v5, v64
  v_dot2_f32_bf16 v75, v33, v6, v64
  v_dot2_f32_bf16 v76, v34, v5, v64
  v_dot2_f32_bf16 v77, v34, v6, v64
  v_dot2_f32_bf16 v78, v35, v5, v64
  v_dot2_f32_bf16 v79, v35, v6, v64
  v_mfma_f32_16x16x32_bf16 v[208:211], a[36:39], a[156:159], v[208:211]
  v_mul_f32 v80, v80, v136
  v_mul_f32 v81, v81, v137
  v_mul_f32 v82, v82, v138
  v_mul_f32 v83, v83, v139
  v_mul_f32 v84, v84, v140
  v_mul_f32 v85, v85, v141
  v_mul_f32 v86, v86, v142
  v_mul_f32 v87, v87, v143
  v_mfma_f32_16x16x32_bf16 v[212:215], a[40:43], a[156:159], v[212:215]
  v_cvt_pk_bf16_f32 v28, v80, v81
  v_cvt_pk_bf16_f32 v29, v82, v83
  v_cvt_pk_bf16_f32 v30, v84, v85
  v_cvt_pk_bf16_f32 v31, v86, v87
  v_mfma_f32_16x16x32_bf16 v[216:219], a[44:47], a[156:159], v[216:219]
  ds_write_b128 v8, v[28:31] offset:3072
  v_dot2_f32_bf16 v80, v36, v5, v64
  v_dot2_f32_bf16 v81, v36, v6, v64
  v_dot2_f32_bf16 v82, v37, v5, v64
  v_dot2_f32_bf16 v83, v37, v6, v64
  v_dot2_f32_bf16 v84, v38, v5, v64
  v_dot2_f32_bf16 v85, v38, v6, v64
  v_dot2_f32_bf16 v86, v39, v5, v64
  v_dot2_f32_bf16 v87, v39, v6, v64
  v_mfma_f32_16x16x32_bf16 v[208:211], a[48:51], a[160:163], v[208:211]
  v_mul_f32 v72, v72, v144
  v_mul_f32 v73, v73, v145
  v_mul_f32 v74, v74, v146
  v_mul_f32 v75, v75, v147
  v_mul_f32 v76, v76, v148
  v_mul_f32 v77, v77, v149
  v_mul_f32 v78, v78, v150
  v_mul_f32 v79, v79, v151
  v_mfma_f32_16x16x32_bf16 v[212:215], a[52:55], a[160:163], v[212:215]
  v_cvt_pk_bf16_f32 v32, v72, v73
  v_cvt_pk_bf16_f32 v33, v74, v75
  v_cvt_pk_bf16_f32 v34, v76, v77
  v_cvt_pk_bf16_f32 v35, v78, v79
  v_mfma_f32_16x16x32_bf16 v[216:219], a[56:59], a[160:163], v[216:219]
  ds_write_b128 v8, v[32:35] offset:4096
  v_dot2_f32_bf16 v72, v40, v5, v64
  v_dot2_f32_bf16 v73, v40, v6, v64
  v_dot2_f32_bf16 v74, v41, v5, v64
  v_dot2_f32_bf16 v75, v41, v6, v64
  v_dot2_f32_bf16 v76, v42, v5, v64
  v_dot2_f32_bf16 v77, v42, v6, v64
  v_dot2_f32_bf16 v78, v43, v5, v64
  v_dot2_f32_bf16 v79, v43, v6, v64
  v_mfma_f32_16x16x32_bf16 v[208:211], a[60:63], a[164:167], v[208:211]
  v_mul_f32 v80, v80, v152
  v_mul_f32 v81, v81, v153
  v_mul_f32 v82, v82, v154
  v_mul_f32 v83, v83, v155
  v_mul_f32 v84, v84, v156
  v_mul_f32 v85, v85, v157
  v_mul_f32 v86, v86, v158
  v_mul_f32 v87, v87, v159
  v_mfma_f32_16x16x32_bf16 v[212:215], a[64:67], a[164:167], v[212:215]
  v_cvt_pk_bf16_f32 v36, v80, v81
  v_cvt_pk_bf16_f32 v37, v82, v83
  v_cvt_pk_bf16_f32 v38, v84, v85
  v_cvt_pk_bf16_f32 v39, v86, v87
  v_mfma_f32_16x16x32_bf16 v[216:219], a[68:71], a[164:167], v[216:219]
  ds_write_b128 v8, v[36:39] offset:5120
  v_dot2_f32_bf16 v80, v44, v5, v64
  v_dot2_f32_bf16 v81, v44, v6, v64
  v_dot2_f32_bf16 v82, v45, v5, v64
  v_dot2_f32_bf16 v83, v45, v6, v64
  v_dot2_f32_bf16 v84, v46, v5, v64
  v_dot2_f32_bf16 v85, v46, v6, v64
  v_dot2_f32_bf16 v86, v47, v5, v64
  v_dot2_f32_bf16 v87, v47, v6, v64
  v_mfma_f32_16x16x32_bf16 v[208:211], a[72:75], a[168:171], v[208:211]
  v_mul_f32 v72, v72, v160
  v_mul_f32 v73, v73, v161
  v_mul_f32 v74, v74, v162
  v_mul_f32 v75, v75, v163
  v_mul_f32 v76, v76, v164
  v_mul_f32 v77, v77, v165
  v_mul_f32 v78, v78, v166
  v_mul_f32 v79, v79, v167
  v_mfma_f32_16x16x32_bf16 v[212:215], a[76:79], a[168:171], v[212:215]
  v_cvt_pk_bf16_f32 v40, v72, v73
  v_cvt_pk_bf16_f32 v41, v74, v75
  v_cvt_pk_bf16_f32 v42, v76, v77
  v_cvt_pk_bf16_f32 v43, v78, v79
  v_mfma_f32_16x16x32_bf16 v[216:219], a[80:83], a[168:171], v[216:219]
  ds_write_b128 v8, v[40:43] offset:6144
  v_dot2_f32_bf16 v72, v48, v5, v64
  v_dot2_f32_bf16 v73, v48, v6, v64
  v_dot2_f32_bf16 v74, v49, v5, v64
  v_dot2_f32_bf16 v75, v49, v6, v64
  v_dot2_f32_bf16 v76, v50, v5, v64
  v_dot2_f32_bf16 v77, v50, v6, v64
  v_dot2_f32_bf16 v78, v51, v5, v64
  v_dot2_f32_bf16 v79, v51, v6, v64
  v_mfma_f32_16x16x32_bf16 v[208:211], a[84:87], a[172:175], v[208:211]
  v_mul_f32 v80, v80, v168
  v_mul_f32 v81, v81, v169
  v_mul_f32 v82, v82, v170
  v_mul_f32 v83, v83, v171
  v_mul_f32 v84, v84, v172
  v_mul_f32 v85, v85, v173
  v_mul_f32 v86, v86, v174
  v_mul_f32 v87, v87, v175
  v_mfma_f32_16x16x32_bf16 v[212:215], a[88:91], a[172:175], v[212:215]
  v_cvt_pk_bf16_f32 v44, v80, v81
  v_cvt_pk_bf16_f32 v45, v82, v83
  v_cvt_pk_bf16_f32 v46, v84, v85
  v_cvt_pk_bf16_f32 v47, v86, v87
  v_mfma_f32_16x16x32_bf16 v[216:219], a[92:95], a[172:175], v[216:219]
  ds_write_b128 v8, v[44:47] offset:7168
  v_dot2_f32_bf16 v80, v52, v5, v64
  v_dot2_f32_bf16 v81, v52, v6, v64
  v_dot2_f32_bf16 v82, v53, v5, v64
  v_dot2_f32_bf16 v83, v53, v6, v64
  v_dot2_f32_bf16 v84, v54, v5, v64
  v_dot2_f32_bf16 v85, v54, v6, v64
  v_dot2_f32_bf16 v86, v55, v5, v64
  v_dot2_f32_bf16 v87, v55, v6, v64
  v_mfma_f32_16x16x32_bf16 v[208:211], a[96:99], a[176:179], v[208:211]
  v_mul_f32 v72, v72, v176
  v_mul_f32 v73, v73, v177
  v_mul_f32 v74, v74, v178
  v_mul_f32 v75, v75, v179
  v_mul_f32 v76, v76, v180
  v_mul_f32 v77, v77, v181
  v_mul_f32 v78, v78, v182
  v_mul_f32 v79, v79, v183
  v_mfma_f32_16x16x32_bf16 v[212:215], a[100:103], a[176:179], v[212:215]
  v_cvt_pk_bf16_f32 v48, v72, v73
  v_cvt_pk_bf16_f32 v49, v74, v75
  v_cvt_pk_bf16_f32 v50, v76, v77
  v_cvt_pk_bf16_f32 v51, v78, v79
  v_mfma_f32_16x16x32_bf16 v[216:219], a[104:107], a[176:179], v[216:219]
  ds_write_b128 v8, v[48:51] offset:8192
  v_dot2_f32_bf16 v72, v56, v5, v64
  v_dot2_f32_bf16 v73, v56, v6, v64
  v_dot2_f32_bf16 v74, v57, v5, v64
  v_dot2_f32_bf16 v75, v57, v6, v64
  v_dot2_f32_bf16 v76, v58, v5, v64
  v_dot2_f32_bf16 v77, v58, v6, v64
  v_dot2_f32_bf16 v78, v59, v5, v64
  v_dot2_f32_bf16 v79, v59, v6, v64
  v_mfma_f32_16x16x32_bf16 v[208:211], a[108:111], a[180:183], v[208:211]
  v_mul_f32 v80, v80, v184
  v_mul_f32 v81, v81, v185
  v_mul_f32 v82, v82, v186
  v_mul_f32 v83, v83, v187
  v_mul_f32 v84, v84, v188
  v_mul_f32 v85, v85, v189
  v_mul_f32 v86, v86, v190
  v_mul_f32 v87, v87, v191
  v_mfma_f32_16x16x32_bf16 v[212:215], a[112:115], a[180:183], v[212:215]
  v_cvt_pk_bf16_f32 v52, v80, v81
  v_cvt_pk_bf16_f32 v53, v82, v83
  v_cvt_pk_bf16_f32 v54, v84, v85
  v_cvt_pk_bf16_f32 v55, v86, v87
  v_mfma_f32_16x16x32_bf16 v[216:219], a[116:119], a[180:183], v[216:219]
  ds_write_b128 v8, v[52:55] offset:9216
  v_dot2_f32_bf16 v80, v60, v5, v64
  v_dot2_f32_bf16 v81, v60, v6, v64
  v_dot2_f32_bf16 v82, v61, v5, v64
  v_dot2_f32_bf16 v83, v61, v6, v64
  v_dot2_f32_bf16 v84, v62, v5, v64
  v_dot2_f32_bf16 v85, v62, v6, v64
  v_dot2_f32_bf16 v86, v63, v5, v64
  v_dot2_f32_bf16 v87, v63, v6, v64
  v_mfma_f32_16x16x32_bf16 v[208:211], a[120:123], a[184:187], v[208:211]
  v_mul_f32 v72, v72, v192
  v_mul_f32 v73, v73, v193
  v_mul_f32 v74, v74, v194
  v_mul_f32 v75, v75, v195
  v_mul_f32 v76, v76, v196
  v_mul_f32 v77, v77, v197
  v_mul_f32 v78, v78, v198
  v_mul_f32 v79, v79, v199
  v_mfma_f32_16x16x32_bf16 v[212:215], a[124:127], a[184:187], v[212:215]
  v_cvt_pk_bf16_f32 v56, v72, v73
  v_cvt_pk_bf16_f32 v57, v74, v75
  v_cvt_pk_bf16_f32 v58, v76, v77
  v_cvt_pk_bf16_f32 v59, v78, v79
  v_mfma_f32_16x16x32_bf16 v[216:219], a[128:131], a[184:187], v[216:219]
  ds_write_b128 v8, v[56:59] offset:10240
  s_nop 2
  v_mfma_f32_16x16x32_bf16 v[208:211], a[132:135], a[188:191], v[208:211]
  v_mul_f32 v80, v80, v200
  v_mul_f32 v81, v81, v201
  v_mul_f32 v82, v82, v202
  v_mul_f32 v83, v83, v203
  v_mul_f32 v84, v84, v204
  v_mul_f32 v85, v85, v205
  v_mul_f32 v86, v86, v206
  v_mul_f32 v87, v87, v207
  v_mfma_f32_16x16x32_bf16 v[212:215], a[136:139], a[188:191], v[212:215]
  v_cvt_pk_bf16_f32 v60, v80, v81
  v_cvt_pk_bf16_f32 v61, v82, v83
  v_cvt_pk_bf16_f32 v62, v84, v85
  v_cvt_pk_bf16_f32 v63, v86, v87
  v_mfma_f32_16x16x32_bf16 v[216:219], a[140:143], a[188:191], v[216:219]
  ds_write_b128 v8, v[60:63] offset:11264
  s_waitcnt lgkmcnt(0)
  s_barrier
  ds_read_b32 v220, v9 offset:0
  ds_read_b32 v221, v9 offset:64
  ds_read_b32 v222, v9 offset:128
  ds_read_b32 v223, v9 offset:192
  v_mov_b32 v172, 0xc0135761
  s_mov_b32 s61, 0xbdd2d3e8
  ds_read_b128 v[112:115], v4 offset:0
  ds_read_b128 v[116:119], v4 offset:1024
  ds_read_b128 v[120:123], v4 offset:2048
  ds_read_b128 v[124:127], v4 offset:3072
  ds_read_b128 v[128:131], v4 offset:4096
  ds_read_b128 v[132:135], v4 offset:5120
  ds_read_b128 v[136:139], v4 offset:6144
  s_waitcnt lgkmcnt(6)
  v_mfma_f32_16x16x32_bf16 v[64:67], a[0:3], v[112:115], 0
  v_mfma_f32_16x16x32_bf16 v[68:71], a[4:7], v[112:115], 0
  v_mfma_f32_16x16x32_bf16 v[72:75], a[8:11], v[112:115], 0
  s_add_u32 s75, s39, 4096
  buffer_load_dwordx4 a[192:195], v4, s[12:15], s75 offen offset:0 sc1
  ds_read_b128 v[140:143], v4 offset:7168
  s_waitcnt lgkmcnt(6)
  v_mfma_f32_16x16x32_bf16 v[64:67], a[12:15], v[116:119], v[64:67]
  v_mfma_f32_16x16x32_bf16 v[68:71], a[16:19], v[116:119], v[68:71]
  v_mfma_f32_16x16x32_bf16 v[72:75], a[20:23], v[116:119], v[72:75]
  buffer_load_dwordx4 a[204:207], v4, s[12:15], s75 offen offset:1024 sc1
  ds_read_b128 v[112:115], v4 offset:8192
  s_waitcnt lgkmcnt(6)
  v_mfma_f32_16x16x32_bf16 v[64:67], a[24:27], v[120:123], v[64:67]
  v_mfma_f32_16x16x32_bf16 v[68:71], a[28:31], v[120:123], v[68:71]
  v_mfma_f32_16x16x32_bf16 v[72:75], a[32:35], v[120:123], v[72:75]
  buffer_load_dwordx4 a[216:219], v4, s[12:15], s75 offen offset:2048 sc1
  ds_read_b128 v[116:119], v4 offset:9216
  s_waitcnt lgkmcnt(6)
  v_mfma_f32_16x16x32_bf16 v[64:67], a[36:39], v[124:127], v[64:67]
  v_mfma_f32_16x16x32_bf16 v[68:71], a[40:43], v[124:127], v[68:71]
  v_mfma_f32_16x16x32_bf16 v[72:75], a[44:47], v[124:127], v[72:75]
  ds_read_b128 v[120:123], v4 offset:10240
  s_waitcnt lgkmcnt(6)
  v_mfma_f32_16x16x32_bf16 v[64:67], a[48:51], v[128:131], v[64:67]
  v_mfma_f32_16x16x32_bf16 v[68:71], a[52:55], v[128:131], v[68:71]
  v_mfma_f32_16x16x32_bf16 v[72:75], a[56:59], v[128:131], v[72:75]
  buffer_load_dwordx4 a[228:231], v4, s[12:15], s75 offen offset:3072 sc1
  ds_read_b128 v[124:127], v4 offset:11264
  s_waitcnt lgkmcnt(6)
  v_mfma_f32_16x16x32_bf16 v[64:67], a[60:63], v[132:135], v[64:67]
  v_mfma_f32_16x16x32_bf16 v[68:71], a[64:67], v[132:135], v[68:71]
  v_mfma_f32_16x16x32_bf16 v[72:75], a[68:71], v[132:135], v[72:75]
  s_add_u32 s76, s39, 8192
  buffer_load_dwordx4 a[240:243], v4, s[12:15], s76 offen offset:0 sc1
  ds_read_b128 v[128:131], v4 offset:12288
  s_waitcnt lgkmcnt(6)
  v_mfma_f32_16x16x32_bf16 v[64:67], a[72:75], v[136:139], v[64:67]
  v_mfma_f32_16x16x32_bf16 v[68:71], a[76:79], v[136:139], v[68:71]
  v_mfma_f32_16x16x32_bf16 v[72:75], a[80:83], v[136:139], v[72:75]
  buffer_load_dwordx4 a[252:255], v4, s[12:15], s76 offen offset:1024 sc1
  ds_read_b128 v[132:135], v4 offset:13312
  s_waitcnt lgkmcnt(6)
  v_mfma_f32_16x16x32_bf16 v[64:67], a[84:87], v[140:143], v[64:67]
  v_mfma_f32_16x16x32_bf16 v[68:71], a[88:91], v[140:143], v[68:71]
  v_mfma_f32_16x16x32_bf16 v[72:75], a[92:95], v[140:143], v[72:75]
  ds_read_b128 v[136:139], v4 offset:14336
  s_waitcnt lgkmcnt(6)
  v_mfma_f32_16x16x32_bf16 v[64:67], a[96:99], v[112:115], v[64:67]
  v_mfma_f32_16x16x32_bf16 v[68:71], a[100:103], v[112:115], v[68:71]
  v_mfma_f32_16x16x32_bf16 v[72:75], a[104:107], v[112:115], v[72:75]
  buffer_load_dwordx4 v[232:235], v4, s[12:15], s76 offen offset:2048 sc1
  ds_read_b128 v[140:143], v4 offset:15360
  s_waitcnt lgkmcnt(6)
  v_mfma_f32_16x16x32_bf16 v[64:67], a[108:111], v[116:119], v[64:67]
  v_mfma_f32_16x16x32_bf16 v[68:71], a[112:115], v[116:119], v[68:71]
  v_mfma_f32_16x16x32_bf16 v[72:75], a[116:119], v[116:119], v[72:75]
  buffer_load_dwordx4 v[244:247], v4, s[12:15], s76 offen offset:3072 sc1
  ds_read_b128 v[112:115], v4 offset:16384
  s_waitcnt lgkmcnt(6)
  v_mfma_f32_16x16x32_bf16 v[64:67], a[120:123], v[120:123], v[64:67]
  v_mfma_f32_16x16x32_bf16 v[68:71], a[124:127], v[120:123], v[68:71]
  v_mfma_f32_16x16x32_bf16 v[72:75], a[128:131], v[120:123], v[72:75]
  s_add_u32 s77, s39, 53248
  buffer_load_dwordx4 a[196:199], v4, s[12:15], s77 offen offset:0 sc1
  ds_read_b128 v[116:119], v4 offset:17408
  s_waitcnt lgkmcnt(6)
  v_mfma_f32_16x16x32_bf16 v[64:67], a[132:135], v[124:127], v[64:67]
  v_mfma_f32_16x16x32_bf16 v[68:71], a[136:139], v[124:127], v[68:71]
  v_mfma_f32_16x16x32_bf16 v[72:75], a[140:143], v[124:127], v[72:75]
  ds_read_b128 v[120:123], v4 offset:18432
  s_waitcnt lgkmcnt(6)
  v_mfma_f32_16x16x32_bf16 v[76:79], a[0:3], v[128:131], 0
  v_mfma_f32_16x16x32_bf16 v[80:83], a[4:7], v[128:131], 0
  v_mfma_f32_16x16x32_bf16 v[84:87], a[8:11], v[128:131], 0
  buffer_load_dwordx4 a[208:211], v4, s[12:15], s77 offen offset:1024 sc1
  ds_read_b128 v[124:127], v4 offset:19456
  s_waitcnt lgkmcnt(6)
  v_mfma_f32_16x16x32_bf16 v[76:79], a[12:15], v[132:135], v[76:79]
  v_mfma_f32_16x16x32_bf16 v[80:83], a[16:19], v[132:135], v[80:83]
  v_mfma_f32_16x16x32_bf16 v[84:87], a[20:23], v[132:135], v[84:87]
  buffer_load_dwordx4 a[220:223], v4, s[12:15], s77 offen offset:2048 sc1
  ds_read_b128 v[128:131], v4 offset:20480
  s_waitcnt lgkmcnt(6)
  v_mfma_f32_16x16x32_bf16 v[76:79], a[24:27], v[136:139], v[76:79]
  v_mfma_f32_16x16x32_bf16 v[80:83], a[28:31], v[136:139], v[80:83]
  v_mfma_f32_16x16x32_bf16 v[84:87], a[32:35], v[136:139], v[84:87]
  buffer_load_dwordx4 a[232:235], v4, s[12:15], s77 offen offset:3072 sc1
  ds_read_b128 v[132:135], v4 offset:21504
  s_waitcnt lgkmcnt(6)
  v_mfma_f32_16x16x32_bf16 v[76:79], a[36:39], v[140:143], v[76:79]
  v_fma_f32 v64, v64, v220, v208
  v_fma_f32 v65, v65, v220, v209
  v_fma_f32 v66, v66, v220, v210
  v_fma_f32 v67, v67, v220, v211
  v_mfma_f32_16x16x32_bf16 v[80:83], a[40:43], v[140:143], v[80:83]
  v_fma_f32 v68, v68, v220, v212
  v_fma_f32 v69, v69, v220, v213
  v_fma_f32 v70, v70, v220, v214
  v_fma_f32 v71, v71, v220, v215
  v_mfma_f32_16x16x32_bf16 v[84:87], a[44:47], v[140:143], v[84:87]
  v_fma_f32 v72, v72, v220, v216
  v_fma_f32 v73, v73, v220, v217
  v_fma_f32 v74, v74, v220, v218
  v_fma_f32 v75, v75, v220, v219
  ds_read_b128 v[136:139], v4 offset:22528
  s_waitcnt lgkmcnt(6)
  v_mfma_f32_16x16x32_bf16 v[76:79], a[48:51], v[112:115], v[76:79]
  v_mul_f32 v160, v64, v64
  v_mul_f32 v161, v65, v65
  v_mul_f32 v162, v66, v66
  v_mul_f32 v163, v67, v67
  v_mfma_f32_16x16x32_bf16 v[80:83], a[52:55], v[112:115], v[80:83]
  v_mul_f32 v164, v68, v68
  v_mul_f32 v165, v69, v69
  v_mul_f32 v166, v70, v70
  v_mul_f32 v167, v71, v71
  v_mfma_f32_16x16x32_bf16 v[84:87], a[56:59], v[112:115], v[84:87]
  v_mul_f32 v168, v72, v72
  v_mul_f32 v169, v73, v73
  v_mul_f32 v170, v74, v74
  v_mul_f32 v171, v75, v75
  s_add_u32 s78, s39, 57344
  buffer_load_dwordx4 a[244:247], v4, s[12:15], s78 offen offset:0 sc1
  ds_read_b128 v[140:143], v4 offset:23552
  s_waitcnt lgkmcnt(6)
  v_mfma_f32_16x16x32_bf16 v[76:79], a[60:63], v[116:119], v[76:79]
  v_fma_f32 v160, v160, s61, v172
  v_fma_f32 v161, v161, s61, v172
  v_fma_f32 v162, v162, s61, v172
  v_fma_f32 v163, v163, s61, v172
  v_mfma_f32_16x16x32_bf16 v[80:83], a[64:67], v[116:119], v[80:83]
  v_fma_f32 v164, v164, s61, v172
  v_fma_f32 v165, v165, s61, v172
  v_fma_f32 v166, v166, s61, v172
  v_fma_f32 v167, v167, s61, v172
  v_mfma_f32_16x16x32_bf16 v[84:87], a[68:71], v[116:119], v[84:87]
  v_fma_f32 v168, v168, s61, v172
  v_fma_f32 v169, v169, s61, v172
  v_fma_f32 v170, v170, s61, v172
  v_fma_f32 v171, v171, s61, v172
  buffer_load_dwordx4 v[224:227], v4, s[12:15], s78 offen offset:1024 sc1
  ds_read_b128 v[112:115], v4 offset:24576
  s_waitcnt lgkmcnt(6)
  v_mfma_f32_16x16x32_bf16 v[76:79], a[72:75], v[120:123], v[76:79]
  v_mul_f32 v160, v160, v64
  v_mul_f32 v161, v161, v65
  v_mul_f32 v162, v162, v66
  v_mul_f32 v163, v163, v67
  v_mfma_f32_16x16x32_bf16 v[80:83], a[76:79], v[120:123], v[80:83]
  v_mul_f32 v164, v164, v68
  v_mul_f32 v165, v165, v69
  v_mul_f32 v166, v166, v70
  v_mul_f32 v167, v167, v71
  v_mfma_f32_16x16x32_bf16 v[84:87], a[80:83], v[120:123], v[84:87]
  v_mul_f32 v168, v168, v72
  v_mul_f32 v169, v169, v73
  v_mul_f32 v170, v170, v74
  v_mul_f32 v171, v171, v75
  buffer_load_dwordx4 v[236:239], v4, s[12:15], s78 offen offset:2048 sc1
  ds_read_b128 v[116:119], v4 offset:25600
  s_waitcnt lgkmcnt(6)
  v_mfma_f32_16x16x32_bf16 v[76:79], a[84:87], v[124:127], v[76:79]
  v_exp_f32 v160, v160
  v_exp_f32 v161, v161
  v_exp_f32 v162, v162
  v_exp_f32 v163, v163
  v_mfma_f32_16x16x32_bf16 v[80:83], a[88:91], v[124:127], v[80:83]
  v_exp_f32 v164, v164
  v_exp_f32 v165, v165
  v_exp_f32 v166, v166
  v_exp_f32 v167, v167
  v_mfma_f32_16x16x32_bf16 v[84:87], a[92:95], v[124:127], v[84:87]
  v_exp_f32 v168, v168
  v_exp_f32 v169, v169
  v_exp_f32 v170, v170
  v_exp_f32 v171, v171
  ds_read_b128 v[120:123], v4 offset:26624
  s_waitcnt lgkmcnt(6)
  v_mfma_f32_16x16x32_bf16 v[76:79], a[96:99], v[128:131], v[76:79]
  v_add_f32 v160, 1.0, v160
  v_add_f32 v161, 1.0, v161
  v_add_f32 v162, 1.0, v162
  v_add_f32 v163, 1.0, v163
  v_mfma_f32_16x16x32_bf16 v[80:83], a[100:103], v[128:131], v[80:83]
  v_add_f32 v164, 1.0, v164
  v_add_f32 v165, 1.0, v165
  v_add_f32 v166, 1.0, v166
  v_add_f32 v167, 1.0, v167
  v_mfma_f32_16x16x32_bf16 v[84:87], a[104:107], v[128:131], v[84:87]
  v_add_f32 v168, 1.0, v168
  v_add_f32 v169, 1.0, v169
  v_add_f32 v170, 1.0, v170
  v_add_f32 v171, 1.0, v171
  buffer_load_dwordx4 v[248:251], v4, s[12:15], s78 offen offset:3072 sc1
  ds_read_b128 v[124:127], v4 offset:27648
  s_waitcnt lgkmcnt(6)
  v_mfma_f32_16x16x32_bf16 v[76:79], a[108:111], v[132:135], v[76:79]
  v_rcp_f32 v160, v160
  v_rcp_f32 v161, v161
  v_rcp_f32 v162, v162
  v_rcp_f32 v163, v163
  v_mfma_f32_16x16x32_bf16 v[80:83], a[112:115], v[132:135], v[80:83]
  v_rcp_f32 v164, v164
  v_rcp_f32 v165, v165
  v_rcp_f32 v166, v166
  v_rcp_f32 v167, v167
  v_mfma_f32_16x16x32_bf16 v[84:87], a[116:119], v[132:135], v[84:87]
  v_rcp_f32 v168, v168
  v_rcp_f32 v169, v169
  v_rcp_f32 v170, v170
  v_rcp_f32 v171, v171
  s_add_u32 s79, s39, 102400
  buffer_load_dwordx4 a[200:203], v4, s[12:15], s79 offen offset:0 sc1
  ds_read_b128 v[128:131], v4 offset:28672
  s_waitcnt lgkmcnt(6)
  v_mfma_f32_16x16x32_bf16 v[76:79], a[120:123], v[136:139], v[76:79]
  v_mul_f32 v64, v64, v160
  v_mul_f32 v65, v65, v161
  v_mul_f32 v66, v66, v162
  v_mul_f32 v67, v67, v163
  v_mfma_f32_16x16x32_bf16 v[80:83], a[124:127], v[136:139], v[80:83]
  v_mul_f32 v68, v68, v164
  v_mul_f32 v69, v69, v165
  v_mul_f32 v70, v70, v166
  v_mul_f32 v71, v71, v167
  v_mfma_f32_16x16x32_bf16 v[84:87], a[128:131], v[136:139], v[84:87]
  v_mul_f32 v72, v72, v168
  v_mul_f32 v73, v73, v169
  v_mul_f32 v74, v74, v170
  v_mul_f32 v75, v75, v171
  buffer_load_dwordx4 a[212:215], v4, s[12:15], s79 offen offset:1024 sc1
  ds_read_b128 v[132:135], v4 offset:29696
  s_waitcnt lgkmcnt(6)
  v_mfma_f32_16x16x32_bf16 v[76:79], a[132:135], v[140:143], v[76:79]
  v_cvt_pk_bf16_f32 v64, v64, v65
  v_cvt_pk_bf16_f32 v65, v66, v67
  ds_write_b64 v12, v[64:65] offset:0
  v_cvt_pk_bf16_f32 v68, v68, v69
  v_mfma_f32_16x16x32_bf16 v[80:83], a[136:139], v[140:143], v[80:83]
  v_cvt_pk_bf16_f32 v69, v70, v71
  ds_write_b64 v13, v[68:69] offset:0
  v_cvt_pk_bf16_f32 v72, v72, v73
  v_cvt_pk_bf16_f32 v73, v74, v75
  v_mfma_f32_16x16x32_bf16 v[84:87], a[140:143], v[140:143], v[84:87]
  ds_write_b64 v14, v[72:73] offset:0
  ds_read_b128 v[136:139], v4 offset:30720
  s_waitcnt lgkmcnt(9)
  v_mfma_f32_16x16x32_bf16 v[88:91], a[0:3], v[112:115], 0
  v_mfma_f32_16x16x32_bf16 v[92:95], a[4:7], v[112:115], 0
  v_mfma_f32_16x16x32_bf16 v[96:99], a[8:11], v[112:115], 0
  buffer_load_dwordx4 a[224:227], v4, s[12:15], s79 offen offset:2048 sc1
  ds_read_b128 v[140:143], v4 offset:31744
  s_waitcnt lgkmcnt(9)
  v_mfma_f32_16x16x32_bf16 v[88:91], a[12:15], v[116:119], v[88:91]
  v_mfma_f32_16x16x32_bf16 v[92:95], a[16:19], v[116:119], v[92:95]
  v_mfma_f32_16x16x32_bf16 v[96:99], a[20:23], v[116:119], v[96:99]
  buffer_load_dwordx4 a[236:239], v4, s[12:15], s79 offen offset:3072 sc1
  ds_read_b128 v[112:115], v4 offset:32768
  s_waitcnt lgkmcnt(9)
  v_mfma_f32_16x16x32_bf16 v[88:91], a[24:27], v[120:123], v[88:91]
  v_mfma_f32_16x16x32_bf16 v[92:95], a[28:31], v[120:123], v[92:95]
  v_mfma_f32_16x16x32_bf16 v[96:99], a[32:35], v[120:123], v[96:99]
  s_add_u32 s64, s39, 106496
  buffer_load_dwordx4 a[248:251], v4, s[12:15], s64 offen offset:0 sc1
  ds_read_b128 v[116:119], v4 offset:33792
  s_waitcnt lgkmcnt(9)
  v_mfma_f32_16x16x32_bf16 v[88:91], a[36:39], v[124:127], v[88:91]
  v_fma_f32 v76, v76, v221, v208
  v_fma_f32 v77, v77, v221, v209
  v_fma_f32 v78, v78, v221, v210
  v_fma_f32 v79, v79, v221, v211
  v_mfma_f32_16x16x32_bf16 v[92:95], a[40:43], v[124:127], v[92:95]
  v_fma_f32 v80, v80, v221, v212
  v_fma_f32 v81, v81, v221, v213
  v_fma_f32 v82, v82, v221, v214
  v_fma_f32 v83, v83, v221, v215
  v_mfma_f32_16x16x32_bf16 v[96:99], a[44:47], v[124:127], v[96:99]
  v_fma_f32 v84, v84, v221, v216
  v_fma_f32 v85, v85, v221, v217
  v_fma_f32 v86, v86, v221, v218
  v_fma_f32 v87, v87, v221, v219
  ds_read_b128 v[120:123], v4 offset:34816
  s_waitcnt lgkmcnt(9)
  v_mfma_f32_16x16x32_bf16 v[88:91], a[48:51], v[128:131], v[88:91]
  v_mul_f32 v160, v76, v76
  v_mul_f32 v161, v77, v77
  v_mul_f32 v162, v78, v78
  v_mul_f32 v163, v79, v79
  v_mfma_f32_16x16x32_bf16 v[92:95], a[52:55], v[128:131], v[92:95]
  v_mul_f32 v164, v80, v80
  v_mul_f32 v165, v81, v81
  v_mul_f32 v166, v82, v82
  v_mul_f32 v167, v83, v83
  v_mfma_f32_16x16x32_bf16 v[96:99], a[56:59], v[128:131], v[96:99]
  v_mul_f32 v168, v84, v84
  v_mul_f32 v169, v85, v85
  v_mul_f32 v170, v86, v86
  v_mul_f32 v171, v87, v87
  buffer_load_dwordx4 v[228:231], v4, s[12:15], s64 offen offset:1024 sc1
  ds_read_b128 v[124:127], v4 offset:35840
  s_waitcnt lgkmcnt(9)
  v_mfma_f32_16x16x32_bf16 v[88:91], a[60:63], v[132:135], v[88:91]
  v_fma_f32 v160, v160, s61, v172
  v_fma_f32 v161, v161, s61, v172
  v_fma_f32 v162, v162, s61, v172
  v_fma_f32 v163, v163, s61, v172
  v_mfma_f32_16x16x32_bf16 v[92:95], a[64:67], v[132:135], v[92:95]
  v_fma_f32 v164, v164, s61, v172
  v_fma_f32 v165, v165, s61, v172
  v_fma_f32 v166, v166, s61, v172
  v_fma_f32 v167, v167, s61, v172
  v_mfma_f32_16x16x32_bf16 v[96:99], a[68:71], v[132:135], v[96:99]
  v_fma_f32 v168, v168, s61, v172
  v_fma_f32 v169, v169, s61, v172
  v_fma_f32 v170, v170, s61, v172
  v_fma_f32 v171, v171, s61, v172
  buffer_load_dwordx4 v[240:243], v4, s[12:15], s64 offen offset:2048 sc1
  ds_read_b128 v[128:131], v4 offset:36864
  s_waitcnt lgkmcnt(6)
  v_mfma_f32_16x16x32_bf16 v[88:91], a[72:75], v[136:139], v[88:91]
  v_mul_f32 v160, v160, v76
  v_mul_f32 v161, v161, v77
  v_mul_f32 v162, v162, v78
  v_mul_f32 v163, v163, v79
  v_mfma_f32_16x16x32_bf16 v[92:95], a[76:79], v[136:139], v[92:95]
  v_mul_f32 v164, v164, v80
  v_mul_f32 v165, v165, v81
  v_mul_f32 v166, v166, v82
  v_mul_f32 v167, v167, v83
  v_mfma_f32_16x16x32_bf16 v[96:99], a[80:83], v[136:139], v[96:99]
  v_mul_f32 v168, v168, v84
  v_mul_f32 v169, v169, v85
  v_mul_f32 v170, v170, v86
  v_mul_f32 v171, v171, v87
  buffer_load_dwordx4 v[252:255], v4, s[12:15], s64 offen offset:3072 sc1
  ds_read_b128 v[132:135], v4 offset:37888
  s_waitcnt lgkmcnt(6)
  v_mfma_f32_16x16x32_bf16 v[88:91], a[84:87], v[140:143], v[88:91]
  v_exp_f32 v160, v160
  v_exp_f32 v161, v161
  v_exp_f32 v162, v162
  v_exp_f32 v163, v163
  v_mfma_f32_16x16x32_bf16 v[92:95], a[88:91], v[140:143], v[92:95]
  v_exp_f32 v164, v164
  v_exp_f32 v165, v165
  v_exp_f32 v166, v166
  v_exp_f32 v167, v167
  v_mfma_f32_16x16x32_bf16 v[96:99], a[92:95], v[140:143], v[96:99]
  v_exp_f32 v168, v168
  v_exp_f32 v169, v169
  v_exp_f32 v170, v170
  v_exp_f32 v171, v171
  ds_read_b128 v[136:139], v4 offset:38912
  s_waitcnt lgkmcnt(6)
  v_mfma_f32_16x16x32_bf16 v[88:91], a[96:99], v[112:115], v[88:91]
  v_add_f32 v160, 1.0, v160
  v_add_f32 v161, 1.0, v161
  v_add_f32 v162, 1.0, v162
  v_add_f32 v163, 1.0, v163
  v_mfma_f32_16x16x32_bf16 v[92:95], a[100:103], v[112:115], v[92:95]
  v_add_f32 v164, 1.0, v164
  v_add_f32 v165, 1.0, v165
  v_add_f32 v166, 1.0, v166
  v_add_f32 v167, 1.0, v167
  v_mfma_f32_16x16x32_bf16 v[96:99], a[104:107], v[112:115], v[96:99]
  v_add_f32 v168, 1.0, v168
  v_add_f32 v169, 1.0, v169
  v_add_f32 v170, 1.0, v170
  v_add_f32 v171, 1.0, v171
  s_add_u32 s65, s39, 0
  buffer_load_dwordx4 a[144:147], v4, s[12:15], s65 offen offset:0 sc1
  ds_read_b128 v[140:143], v4 offset:39936
  s_waitcnt lgkmcnt(6)
  v_mfma_f32_16x16x32_bf16 v[88:91], a[108:111], v[116:119], v[88:91]
  v_rcp_f32 v160, v160
  v_rcp_f32 v161, v161
  v_rcp_f32 v162, v162
  v_rcp_f32 v163, v163
  v_mfma_f32_16x16x32_bf16 v[92:95], a[112:115], v[116:119], v[92:95]
  v_rcp_f32 v164, v164
  v_rcp_f32 v165, v165
  v_rcp_f32 v166, v166
  v_rcp_f32 v167, v167
  v_mfma_f32_16x16x32_bf16 v[96:99], a[116:119], v[116:119], v[96:99]
  v_rcp_f32 v168, v168
  v_rcp_f32 v169, v169
  v_rcp_f32 v170, v170
  v_rcp_f32 v171, v171
  buffer_load_dwordx4 a[156:159], v4, s[12:15], s65 offen offset:1024 sc1
  ds_read_b128 v[112:115], v4 offset:40960
  s_waitcnt lgkmcnt(6)
  v_mfma_f32_16x16x32_bf16 v[88:91], a[120:123], v[120:123], v[88:91]
  v_mul_f32 v76, v76, v160
  v_mul_f32 v77, v77, v161
  v_mul_f32 v78, v78, v162
  v_mul_f32 v79, v79, v163
  v_mfma_f32_16x16x32_bf16 v[92:95], a[124:127], v[120:123], v[92:95]
  v_mul_f32 v80, v80, v164
  v_mul_f32 v81, v81, v165
  v_mul_f32 v82, v82, v166
  v_mul_f32 v83, v83, v167
  v_mfma_f32_16x16x32_bf16 v[96:99], a[128:131], v[120:123], v[96:99]
  v_mul_f32 v84, v84, v168
  v_mul_f32 v85, v85, v169
  v_mul_f32 v86, v86, v170
  v_mul_f32 v87, v87, v171
  buffer_load_dwordx4 a[168:171], v4, s[12:15], s65 offen offset:2048 sc1
  ds_read_b128 v[116:119], v4 offset:41984
  s_waitcnt lgkmcnt(6)
  v_mfma_f32_16x16x32_bf16 v[88:91], a[132:135], v[124:127], v[88:91]
  v_cvt_pk_bf16_f32 v76, v76, v77
  v_cvt_pk_bf16_f32 v77, v78, v79
  ds_write_b64 v12, v[76:77] offset:6144
  v_cvt_pk_bf16_f32 v80, v80, v81
  v_mfma_f32_16x16x32_bf16 v[92:95], a[136:139], v[124:127], v[92:95]
  v_cvt_pk_bf16_f32 v81, v82, v83
  ds_write_b64 v13, v[80:81] offset:6144
  v_cvt_pk_bf16_f32 v84, v84, v85
  v_cvt_pk_bf16_f32 v85, v86, v87
  v_mfma_f32_16x16x32_bf16 v[96:99], a[140:143], v[124:127], v[96:99]
  ds_write_b64 v14, v[84:85] offset:6144
  ds_read_b128 v[120:123], v4 offset:43008
  s_waitcnt lgkmcnt(9)
  v_mfma_f32_16x16x32_bf16 v[100:103], a[0:3], v[128:131], 0
  v_mfma_f32_16x16x32_bf16 v[104:107], a[4:7], v[128:131], 0
  v_mfma_f32_16x16x32_bf16 v[108:111], a[8:11], v[128:131], 0
  buffer_load_dwordx4 a[180:183], v4, s[12:15], s65 offen offset:3072 sc1
  ds_read_b128 v[124:127], v4 offset:44032
  s_waitcnt lgkmcnt(9)
  v_mfma_f32_16x16x32_bf16 v[100:103], a[12:15], v[132:135], v[100:103]
  v_mfma_f32_16x16x32_bf16 v[104:107], a[16:19], v[132:135], v[104:107]
  v_mfma_f32_16x16x32_bf16 v[108:111], a[20:23], v[132:135], v[108:111]
  s_add_u32 s66, s39, 49152
  buffer_load_dwordx4 a[148:151], v4, s[12:15], s66 offen offset:0 sc1
  ds_read_b128 v[128:131], v4 offset:45056
  s_waitcnt lgkmcnt(9)
  v_mfma_f32_16x16x32_bf16 v[100:103], a[24:27], v[136:139], v[100:103]
  v_mfma_f32_16x16x32_bf16 v[104:107], a[28:31], v[136:139], v[104:107]
  v_mfma_f32_16x16x32_bf16 v[108:111], a[32:35], v[136:139], v[108:111]
  buffer_load_dwordx4 a[160:163], v4, s[12:15], s66 offen offset:1024 sc1
  ds_read_b128 v[132:135], v4 offset:46080
  s_waitcnt lgkmcnt(9)
  v_mfma_f32_16x16x32_bf16 v[100:103], a[36:39], v[140:143], v[100:103]
  v_fma_f32 v88, v88, v222, v208
  v_fma_f32 v89, v89, v222, v209
  v_fma_f32 v90, v90, v222, v210
  v_fma_f32 v91, v91, v222, v211
  v_mfma_f32_16x16x32_bf16 v[104:107], a[40:43], v[140:143], v[104:107]
  v_fma_f32 v92, v92, v222, v212
  v_fma_f32 v93, v93, v222, v213
  v_fma_f32 v94, v94, v222, v214
  v_fma_f32 v95, v95, v222, v215
  v_mfma_f32_16x16x32_bf16 v[108:111], a[44:47], v[140:143], v[108:111]
  v_fma_f32 v96, v96, v222, v216
  v_fma_f32 v97, v97, v222, v217
  v_fma_f32 v98, v98, v222, v218
  v_fma_f32 v99, v99, v222, v219
  ds_read_b128 v[136:139], v4 offset:47104
  s_waitcnt lgkmcnt(9)
  v_mfma_f32_16x16x32_bf16 v[100:103], a[48:51], v[112:115], v[100:103]
  v_mul_f32 v160, v88, v88
  v_mul_f32 v161, v89, v89
  v_mul_f32 v162, v90, v90
  v_mul_f32 v163, v91, v91
  v_mfma_f32_16x16x32_bf16 v[104:107], a[52:55], v[112:115], v[104:107]
  v_mul_f32 v164, v92, v92
  v_mul_f32 v165, v93, v93
  v_mul_f32 v166, v94, v94
  v_mul_f32 v167, v95, v95
  v_mfma_f32_16x16x32_bf16 v[108:111], a[56:59], v[112:115], v[108:111]
  v_mul_f32 v168, v96, v96
  v_mul_f32 v169, v97, v97
  v_mul_f32 v170, v98, v98
  v_mul_f32 v171, v99, v99
  buffer_load_dwordx4 a[172:175], v4, s[12:15], s66 offen offset:2048 sc1
  ds_read_b128 v[140:143], v4 offset:48128
  s_waitcnt lgkmcnt(9)
  v_mfma_f32_16x16x32_bf16 v[100:103], a[60:63], v[116:119], v[100:103]
  v_fma_f32 v160, v160, s61, v172
  v_fma_f32 v161, v161, s61, v172
  v_fma_f32 v162, v162, s61, v172
  v_fma_f32 v163, v163, s61, v172
  v_mfma_f32_16x16x32_bf16 v[104:107], a[64:67], v[116:119], v[104:107]
  v_fma_f32 v164, v164, s61, v172
  v_fma_f32 v165, v165, s61, v172
  v_fma_f32 v166, v166, s61, v172
  v_fma_f32 v167, v167, s61, v172
  v_mfma_f32_16x16x32_bf16 v[108:111], a[68:71], v[116:119], v[108:111]
  v_fma_f32 v168, v168, s61, v172
  v_fma_f32 v169, v169, s61, v172
  v_fma_f32 v170, v170, s61, v172
  v_fma_f32 v171, v171, s61, v172
  buffer_load_dwordx4 a[184:187], v4, s[12:15], s66 offen offset:3072 sc1
  s_waitcnt lgkmcnt(5)
  v_mfma_f32_16x16x32_bf16 v[100:103], a[72:75], v[120:123], v[100:103]
  v_mul_f32 v160, v160, v88
  v_mul_f32 v161, v161, v89
  v_mul_f32 v162, v162, v90
  v_mul_f32 v163, v163, v91
  v_mfma_f32_16x16x32_bf16 v[104:107], a[76:79], v[120:123], v[104:107]
  v_mul_f32 v164, v164, v92
  v_mul_f32 v165, v165, v93
  v_mul_f32 v166, v166, v94
  v_mul_f32 v167, v167, v95
  v_mfma_f32_16x16x32_bf16 v[108:111], a[80:83], v[120:123], v[108:111]
  v_mul_f32 v168, v168, v96
  v_mul_f32 v169, v169, v97
  v_mul_f32 v170, v170, v98
  v_mul_f32 v171, v171, v99
  s_add_u32 s67, s39, 98304
  buffer_load_dwordx4 a[152:155], v4, s[12:15], s67 offen offset:0 sc1
  s_waitcnt lgkmcnt(4)
  v_mfma_f32_16x16x32_bf16 v[100:103], a[84:87], v[124:127], v[100:103]
  v_exp_f32 v160, v160
  v_exp_f32 v161, v161
  v_exp_f32 v162, v162
  v_exp_f32 v163, v163
  v_mfma_f32_16x16x32_bf16 v[104:107], a[88:91], v[124:127], v[104:107]
  v_exp_f32 v164, v164
  v_exp_f32 v165, v165
  v_exp_f32 v166, v166
  v_exp_f32 v167, v167
  v_mfma_f32_16x16x32_bf16 v[108:111], a[92:95], v[124:127], v[108:111]
  v_exp_f32 v168, v168
  v_exp_f32 v169, v169
  v_exp_f32 v170, v170
  v_exp_f32 v171, v171
  s_waitcnt lgkmcnt(3)
  v_mfma_f32_16x16x32_bf16 v[100:103], a[96:99], v[128:131], v[100:103]
  v_add_f32 v160, 1.0, v160
  v_add_f32 v161, 1.0, v161
  v_add_f32 v162, 1.0, v162
  v_add_f32 v163, 1.0, v163
  v_mfma_f32_16x16x32_bf16 v[104:107], a[100:103], v[128:131], v[104:107]
  v_add_f32 v164, 1.0, v164
  v_add_f32 v165, 1.0, v165
  v_add_f32 v166, 1.0, v166
  v_add_f32 v167, 1.0, v167
  v_mfma_f32_16x16x32_bf16 v[108:111], a[104:107], v[128:131], v[108:111]
  v_add_f32 v168, 1.0, v168
  v_add_f32 v169, 1.0, v169
  v_add_f32 v170, 1.0, v170
  v_add_f32 v171, 1.0, v171
  buffer_load_dwordx4 a[164:167], v4, s[12:15], s67 offen offset:1024 sc1
  s_waitcnt lgkmcnt(2)
  v_mfma_f32_16x16x32_bf16 v[100:103], a[108:111], v[132:135], v[100:103]
  v_rcp_f32 v160, v160
  v_rcp_f32 v161, v161
  v_rcp_f32 v162, v162
  v_rcp_f32 v163, v163
  v_mfma_f32_16x16x32_bf16 v[104:107], a[112:115], v[132:135], v[104:107]
  v_rcp_f32 v164, v164
  v_rcp_f32 v165, v165
  v_rcp_f32 v166, v166
  v_rcp_f32 v167, v167
  v_mfma_f32_16x16x32_bf16 v[108:111], a[116:119], v[132:135], v[108:111]
  v_rcp_f32 v168, v168
  v_rcp_f32 v169, v169
  v_rcp_f32 v170, v170
  v_rcp_f32 v171, v171
  buffer_load_dwordx4 a[176:179], v4, s[12:15], s67 offen offset:2048 sc1
  s_waitcnt lgkmcnt(1)
  v_mfma_f32_16x16x32_bf16 v[100:103], a[120:123], v[136:139], v[100:103]
  v_mul_f32 v88, v88, v160
  v_mul_f32 v89, v89, v161
  v_mul_f32 v90, v90, v162
  v_mul_f32 v91, v91, v163
  v_mfma_f32_16x16x32_bf16 v[104:107], a[124:127], v[136:139], v[104:107]
  v_mul_f32 v92, v92, v164
  v_mul_f32 v93, v93, v165
  v_mul_f32 v94, v94, v166
  v_mul_f32 v95, v95, v167
  v_mfma_f32_16x16x32_bf16 v[108:111], a[128:131], v[136:139], v[108:111]
  v_mul_f32 v96, v96, v168
  v_mul_f32 v97, v97, v169
  v_mul_f32 v98, v98, v170
  v_mul_f32 v99, v99, v171
  buffer_load_dwordx4 a[188:191], v4, s[12:15], s67 offen offset:3072 sc1
  s_waitcnt lgkmcnt(0)
  v_mfma_f32_16x16x32_bf16 v[100:103], a[132:135], v[140:143], v[100:103]
  v_cvt_pk_bf16_f32 v88, v88, v89
  v_cvt_pk_bf16_f32 v89, v90, v91
  ds_write_b64 v12, v[88:89] offset:12288
  v_cvt_pk_bf16_f32 v92, v92, v93
  v_mfma_f32_16x16x32_bf16 v[104:107], a[136:139], v[140:143], v[104:107]
  v_cvt_pk_bf16_f32 v93, v94, v95
  ds_write_b64 v13, v[92:93] offset:12288
  v_cvt_pk_bf16_f32 v96, v96, v97
  v_cvt_pk_bf16_f32 v97, v98, v99
  v_mfma_f32_16x16x32_bf16 v[108:111], a[140:143], v[140:143], v[108:111]
  ds_write_b64 v14, v[96:97] offset:12288
  s_nop 7
  v_fma_f32 v100, v100, v223, v208
  v_fma_f32 v101, v101, v223, v209
  v_fma_f32 v102, v102, v223, v210
  v_fma_f32 v103, v103, v223, v211
  v_fma_f32 v104, v104, v223, v212
  v_fma_f32 v105, v105, v223, v213
  v_fma_f32 v106, v106, v223, v214
  v_fma_f32 v107, v107, v223, v215
  v_fma_f32 v108, v108, v223, v216
  v_fma_f32 v109, v109, v223, v217
  v_fma_f32 v110, v110, v223, v218
  v_fma_f32 v111, v111, v223, v219
  v_mul_f32 v160, v100, v100
  v_mul_f32 v161, v101, v101
  v_mul_f32 v162, v102, v102
  v_mul_f32 v163, v103, v103
  v_mul_f32 v164, v104, v104
  v_mul_f32 v165, v105, v105
  v_mul_f32 v166, v106, v106
  v_mul_f32 v167, v107, v107
  v_mul_f32 v168, v108, v108
  v_mul_f32 v169, v109, v109
  v_mul_f32 v170, v110, v110
  v_mul_f32 v171, v111, v111
  v_fma_f32 v160, v160, s61, v172
  v_fma_f32 v161, v161, s61, v172
  v_fma_f32 v162, v162, s61, v172
  v_fma_f32 v163, v163, s61, v172
  v_fma_f32 v164, v164, s61, v172
  v_fma_f32 v165, v165, s61, v172
  v_fma_f32 v166, v166, s61, v172
  v_fma_f32 v167, v167, s61, v172
  v_fma_f32 v168, v168, s61, v172
  v_fma_f32 v169, v169, s61, v172
  v_fma_f32 v170, v170, s61, v172
  v_fma_f32 v171, v171, s61, v172
  v_mul_f32 v160, v160, v100
  v_mul_f32 v161, v161, v101
  v_mul_f32 v162, v162, v102
  v_mul_f32 v163, v163, v103
  v_mul_f32 v164, v164, v104
  v_mul_f32 v165, v165, v105
  v_mul_f32 v166, v166, v106
  v_mul_f32 v167, v167, v107
  v_mul_f32 v168, v168, v108
  v_mul_f32 v169, v169, v109
  v_mul_f32 v170, v170, v110
  v_mul_f32 v171, v171, v111
  v_exp_f32 v160, v160
  v_exp_f32 v161, v161
  v_exp_f32 v162, v162
  v_exp_f32 v163, v163
  v_exp_f32 v164, v164
  v_exp_f32 v165, v165
  v_exp_f32 v166, v166
  v_exp_f32 v167, v167
  v_exp_f32 v168, v168
  v_exp_f32 v169, v169
  v_exp_f32 v170, v170
  v_exp_f32 v171, v171
  v_add_f32 v160, 1.0, v160
  v_add_f32 v161, 1.0, v161
  v_add_f32 v162, 1.0, v162
  v_add_f32 v163, 1.0, v163
  v_add_f32 v164, 1.0, v164
  v_add_f32 v165, 1.0, v165
  v_add_f32 v166, 1.0, v166
  v_add_f32 v167, 1.0, v167
  v_add_f32 v168, 1.0, v168
  v_add_f32 v169, 1.0, v169
  v_add_f32 v170, 1.0, v170
  v_add_f32 v171, 1.0, v171
  v_rcp_f32 v160, v160
  v_rcp_f32 v161, v161
  v_rcp_f32 v162, v162
  v_rcp_f32 v163, v163
  v_rcp_f32 v164, v164
  v_rcp_f32 v165, v165
  v_rcp_f32 v166, v166
  v_rcp_f32 v167, v167
  v_rcp_f32 v168, v168
  v_rcp_f32 v169, v169
  v_rcp_f32 v170, v170
  v_rcp_f32 v171, v171
  v_mul_f32 v100, v100, v160
  v_mul_f32 v101, v101, v161
  v_mul_f32 v102, v102, v162
  v_mul_f32 v103, v103, v163
  v_mul_f32 v104, v104, v164
  v_mul_f32 v105, v105, v165
  v_mul_f32 v106, v106, v166
  v_mul_f32 v107, v107, v167
  v_mul_f32 v108, v108, v168
  v_mul_f32 v109, v109, v169
  v_mul_f32 v110, v110, v170
  v_mul_f32 v111, v111, v171
  v_cvt_pk_bf16_f32 v100, v100, v101
  v_cvt_pk_bf16_f32 v101, v102, v103
  ds_write_b64 v12, v[100:101] offset:18432
  v_cvt_pk_bf16_f32 v104, v104, v105
  v_cvt_pk_bf16_f32 v105, v106, v107
  ds_write_b64 v13, v[104:105] offset:18432
  v_cvt_pk_bf16_f32 v108, v108, v109
  v_cvt_pk_bf16_f32 v109, v110, v111
  ds_write_b64 v14, v[108:109] offset:18432
  s_mul_i32 s52, s3, 49152
  s_add_u32 s52, s52, s30
  s_add_u32 s53, s52, 4096
  s_waitcnt lgkmcnt(0)
  s_barrier
  ds_read_b128 v[112:115], v15 offset:0
  ds_read_b128 v[116:119], v15 offset:1024
  ds_read_b128 v[120:123], v15 offset:2048
  ds_read_b128 v[124:127], v15 offset:3072
  ds_read_b128 v[128:131], v15 offset:4096
  ds_read_b128 v[132:135], v15 offset:5120
  s_cmp_eq_u32 s63, 1
  s_cbranch_scc1 mega_kernel_dfsg
  s_waitcnt lgkmcnt(5)
  buffer_store_dwordx4 v[112:115], v4, s[12:15], s52 offen offset:0 sc1
  s_waitcnt lgkmcnt(4)
  buffer_store_dwordx4 v[116:119], v4, s[12:15], s52 offen offset:1024 sc1
  s_waitcnt lgkmcnt(3)
  buffer_store_dwordx4 v[120:123], v4, s[12:15], s52 offen offset:2048 sc1
  s_waitcnt lgkmcnt(2)
  buffer_store_dwordx4 v[124:127], v4, s[12:15], s52 offen offset:3072 sc1
  s_waitcnt lgkmcnt(1)
  buffer_store_dwordx4 v[128:131], v4, s[12:15], s53 offen offset:0 sc1
  s_waitcnt lgkmcnt(0)
  buffer_store_dwordx4 v[132:135], v4, s[12:15], s53 offen offset:1024 sc1
  s_branch mega_kernel_desg
mega_kernel_dfsg:
  s_waitcnt lgkmcnt(5)
  buffer_store_dwordx4 v[112:115], v4, s[12:15], s52 offen offset:0
  s_waitcnt lgkmcnt(4)
  buffer_store_dwordx4 v[116:119], v4, s[12:15], s52 offen offset:1024
  s_waitcnt lgkmcnt(3)
  buffer_store_dwordx4 v[120:123], v4, s[12:15], s52 offen offset:2048
  s_waitcnt lgkmcnt(2)
  buffer_store_dwordx4 v[124:127], v4, s[12:15], s52 offen offset:3072
  s_waitcnt lgkmcnt(1)
  buffer_store_dwordx4 v[128:131], v4, s[12:15], s53 offen offset:0
  s_waitcnt lgkmcnt(0)
  buffer_store_dwordx4 v[132:135], v4, s[12:15], s53 offen offset:1024
mega_kernel_desg:
  s_lshl_b32 s56, s20, 7
  s_lshl_b32 s57, s21, 2
  s_add_u32 s56, s56, s57
  s_add_u32 s56, s56, 45056
  v_mov_b32 v10, 0
  v_mov_b32 v11, 1
  s_cmp_lg_u32 s3, 0
  s_waitcnt vmcnt(0)
  s_barrier
  s_cbranch_scc1 mega_kernel_pubf
  s_mov_b64 exec, 1
  s_cmp_eq_u32 s63, 1
  s_cbranch_scc1 mega_kernel_dfpf
  buffer_store_dword v11, v10, s[12:15], s56 offen sc1
  s_branch mega_kernel_depf
mega_kernel_dfpf:
  buffer_store_dword v11, v10, s[12:15], s56 offen
mega_kernel_depf:
  s_mov_b64 exec, -1
mega_kernel_pubf:
  s_lshl_b32 s46, s20, 2
  s_add_u32 s46, s46, s3
  s_mul_i32 s46, s46, 12288
  s_mul_i32 s25, s21, 1536
  s_add_u32 s25, s25, s46
  s_add_u32 s25, s25, 2752512
  s_mul_i32 s24, s21, 96
  s_add_u32 s46, s46, s24
  s_mul_i32 s25, s21, 1536
  s_add_u32 s25, s25, s34
  s_mul_i32 s26, s47, 9216
  s_mul_i32 s27, s21, 192
  s_add_u32 s26, s26, s27
  s_add_u32 s26, s26, 7680
  s_mul_i32 s28, s3, 12288
  s_add_u32 s29, s29, s28
  s_add_u32 s29, s29, 9175040
  v_and_b32 v10, 1, v1
  s_lshl_b32 s57, s3, 3
  v_lshlrev_b32 v10, 2, v10
  s_lshl_b32 s58, s20, 7
  s_add_u32 s58, s58, s57
  v_add_u32 v10, s58, v10
  s_mov_b32 s56, 45056
  s_mov_b32 s57, 0x100000
mega_kernel_plg:
  buffer_load_dword v11, v10, s[12:15], s56 offen sc1
  s_waitcnt vmcnt(0)
  v_cmp_ne_u32 vcc, 1, v11
  s_sub_u32 s57, s57, 1
  s_cbranch_scc1 mega_kernel_pdg
  s_cbranch_vccz mega_kernel_pdg
  s_sleep 1
  s_branch mega_kernel_plg
mega_kernel_pdg:
  s_add_u32 s64, s29, 0
  buffer_load_dwordx4 v[64:67], v4, s[12:15], s64 offen offset:0 sc1
  buffer_load_dwordx4 v[80:83], v4, s[12:15], s64 offen offset:1024 sc1
  s_add_u32 s65, s29, 49152
  buffer_load_dwordx4 v[68:71], v4, s[12:15], s65 offen offset:0 sc1
  buffer_load_dwordx4 v[84:87], v4, s[12:15], s65 offen offset:1024 sc1
  s_add_u32 s66, s29, 98304
  buffer_load_dwordx4 v[72:75], v4, s[12:15], s66 offen offset:0 sc1
  buffer_load_dwordx4 v[88:91], v4, s[12:15], s66 offen offset:1024 sc1
  s_add_u32 s67, s29, 147456
  buffer_load_dwordx4 v[76:79], v4, s[12:15], s67 offen offset:0 sc1
  buffer_load_dwordx4 v[92:95], v4, s[12:15], s67 offen offset:1024 sc1
  buffer_load_dwordx4 v[96:99], v4, s[12:15], s64 offen offset:2048 sc1
  buffer_load_dwordx4 v[112:115], v4, s[12:15], s64 offen offset:3072 sc1
  buffer_load_dwordx4 v[100:103], v4, s[12:15], s65 offen offset:2048 sc1
  buffer_load_dwordx4 v[116:119], v4, s[12:15], s65 offen offset:3072 sc1
  buffer_load_dwordx4 v[104:107], v4, s[12:15], s66 offen offset:2048 sc1
  buffer_load_dwordx4 v[120:123], v4, s[12:15], s66 offen offset:3072 sc1
  buffer_load_dwordx4 v[108:111], v4, s[12:15], s67 offen offset:2048 sc1
  buffer_load_dwordx4 v[124:127], v4, s[12:15], s67 offen offset:3072 sc1
  s_add_u32 s68, s29, 4096
  buffer_load_dwordx4 v[128:131], v4, s[12:15], s68 offen offset:0 sc1
  buffer_load_dwordx4 v[144:147], v4, s[12:15], s68 offen offset:1024 sc1
  s_add_u32 s69, s29, 53248
  buffer_load_dwordx4 v[132:135], v4, s[12:15], s69 offen offset:0 sc1
  buffer_load_dwordx4 v[148:151], v4, s[12:15], s69 offen offset:1024 sc1
  s_add_u32 s70, s29, 102400
  buffer_load_dwordx4 v[136:139], v4, s[12:15], s70 offen offset:0 sc1
  buffer_load_dwordx4 v[152:155], v4, s[12:15], s70 offen offset:1024 sc1
  s_add_u32 s71, s29, 151552
  buffer_load_dwordx4 v[140:143], v4, s[12:15], s71 offen offset:0 sc1
  buffer_load_dwordx4 v[156:159], v4, s[12:15], s71 offen offset:1024 sc1
  s_waitcnt vmcnt(17)
  v_mfma_f32_16x16x32_bf16 v[16:19], a[144:147], v[64:67], 0
  v_mfma_f32_16x16x32_bf16 v[20:23], a[148:151], v[64:67], 0
  v_mfma_f32_16x16x32_bf16 v[24:27], a[152:155], v[64:67], 0
  buffer_load_dwordx4 v[160:163], v4, s[12:15], s68 offen offset:2048 sc1
  v_mfma_f32_16x16x32_bf16 v[28:31], a[144:147], v[68:71], 0
  v_mfma_f32_16x16x32_bf16 v[32:35], a[148:151], v[68:71], 0
  v_mfma_f32_16x16x32_bf16 v[36:39], a[152:155], v[68:71], 0
  buffer_load_dwordx4 v[176:179], v4, s[12:15], s68 offen offset:3072 sc1
  v_mfma_f32_16x16x32_bf16 v[40:43], a[144:147], v[72:75], 0
  v_mfma_f32_16x16x32_bf16 v[44:47], a[148:151], v[72:75], 0
  v_mfma_f32_16x16x32_bf16 v[48:51], a[152:155], v[72:75], 0
  buffer_load_dwordx4 v[164:167], v4, s[12:15], s69 offen offset:2048 sc1
  v_mfma_f32_16x16x32_bf16 v[52:55], a[144:147], v[76:79], 0
  v_mfma_f32_16x16x32_bf16 v[56:59], a[148:151], v[76:79], 0
  v_mfma_f32_16x16x32_bf16 v[60:63], a[152:155], v[76:79], 0
  buffer_load_dwordx4 v[180:183], v4, s[12:15], s69 offen offset:3072 sc1
  s_waitcnt vmcnt(20)
  v_mfma_f32_16x16x32_bf16 v[16:19], a[156:159], v[80:83], v[16:19]
  v_mfma_f32_16x16x32_bf16 v[20:23], a[160:163], v[80:83], v[20:23]
  v_mfma_f32_16x16x32_bf16 v[24:27], a[164:167], v[80:83], v[24:27]
  buffer_load_dwordx4 v[168:171], v4, s[12:15], s70 offen offset:2048 sc1
  v_mfma_f32_16x16x32_bf16 v[28:31], a[156:159], v[84:87], v[28:31]
  v_mfma_f32_16x16x32_bf16 v[32:35], a[160:163], v[84:87], v[32:35]
  v_mfma_f32_16x16x32_bf16 v[36:39], a[164:167], v[84:87], v[36:39]
  buffer_load_dwordx4 v[184:187], v4, s[12:15], s70 offen offset:3072 sc1
  v_mfma_f32_16x16x32_bf16 v[40:43], a[156:159], v[88:91], v[40:43]
  v_mfma_f32_16x16x32_bf16 v[44:47], a[160:163], v[88:91], v[44:47]
  v_mfma_f32_16x16x32_bf16 v[48:51], a[164:167], v[88:91], v[48:51]
  buffer_load_dwordx4 v[172:175], v4, s[12:15], s71 offen offset:2048 sc1
  v_mfma_f32_16x16x32_bf16 v[52:55], a[156:159], v[92:95], v[52:55]
  v_mfma_f32_16x16x32_bf16 v[56:59], a[160:163], v[92:95], v[56:59]
  v_mfma_f32_16x16x32_bf16 v[60:63], a[164:167], v[92:95], v[60:63]
  buffer_load_dwordx4 v[188:191], v4, s[12:15], s71 offen offset:3072 sc1
  s_waitcnt vmcnt(17)
  v_mfma_f32_16x16x32_bf16 v[16:19], a[168:171], v[96:99], v[16:19]
  v_mfma_f32_16x16x32_bf16 v[20:23], a[172:175], v[96:99], v[20:23]
  v_mfma_f32_16x16x32_bf16 v[24:27], a[176:179], v[96:99], v[24:27]
  s_add_u32 s72, s29, 8192
  buffer_load_dwordx4 v[192:195], v4, s[12:15], s72 offen offset:0 sc1
  v_mfma_f32_16x16x32_bf16 v[28:31], a[168:171], v[100:103], v[28:31]
  v_mfma_f32_16x16x32_bf16 v[32:35], a[172:175], v[100:103], v[32:35]
  v_mfma_f32_16x16x32_bf16 v[36:39], a[176:179], v[100:103], v[36:39]
  buffer_load_dwordx4 v[208:211], v4, s[12:15], s72 offen offset:1024 sc1
  v_mfma_f32_16x16x32_bf16 v[40:43], a[168:171], v[104:107], v[40:43]
  v_mfma_f32_16x16x32_bf16 v[44:47], a[172:175], v[104:107], v[44:47]
  v_mfma_f32_16x16x32_bf16 v[48:51], a[176:179], v[104:107], v[48:51]
  s_add_u32 s73, s29, 57344
  buffer_load_dwordx4 v[196:199], v4, s[12:15], s73 offen offset:0 sc1
  v_mfma_f32_16x16x32_bf16 v[52:55], a[168:171], v[108:111], v[52:55]
  v_mfma_f32_16x16x32_bf16 v[56:59], a[172:175], v[108:111], v[56:59]
  v_mfma_f32_16x16x32_bf16 v[60:63], a[176:179], v[108:111], v[60:63]
  buffer_load_dwordx4 v[212:215], v4, s[12:15], s73 offen offset:1024 sc1
  s_waitcnt vmcnt(20)
  v_mfma_f32_16x16x32_bf16 v[16:19], a[180:183], v[112:115], v[16:19]
  v_mfma_f32_16x16x32_bf16 v[20:23], a[184:187], v[112:115], v[20:23]
  v_mfma_f32_16x16x32_bf16 v[24:27], a[188:191], v[112:115], v[24:27]
  s_add_u32 s74, s29, 106496
  buffer_load_dwordx4 v[200:203], v4, s[12:15], s74 offen offset:0 sc1
  v_mfma_f32_16x16x32_bf16 v[28:31], a[180:183], v[116:119], v[28:31]
  v_mfma_f32_16x16x32_bf16 v[32:35], a[184:187], v[116:119], v[32:35]
  v_mfma_f32_16x16x32_bf16 v[36:39], a[188:191], v[116:119], v[36:39]
  buffer_load_dwordx4 v[216:219], v4, s[12:15], s74 offen offset:1024 sc1
  v_mfma_f32_16x16x32_bf16 v[40:43], a[180:183], v[120:123], v[40:43]
  v_mfma_f32_16x16x32_bf16 v[44:47], a[184:187], v[120:123], v[44:47]
  v_mfma_f32_16x16x32_bf16 v[48:51], a[188:191], v[120:123], v[48:51]
  s_add_u32 s75, s29, 155648
  buffer_load_dwordx4 v[204:207], v4, s[12:15], s75 offen offset:0 sc1
  v_mfma_f32_16x16x32_bf16 v[52:55], a[180:183], v[124:127], v[52:55]
  v_mfma_f32_16x16x32_bf16 v[56:59], a[184:187], v[124:127], v[56:59]
  v_mfma_f32_16x16x32_bf16 v[60:63], a[188:191], v[124:127], v[60:63]
  buffer_load_dwordx4 v[220:223], v4, s[12:15], s75 offen offset:1024 sc1
  s_waitcnt vmcnt(17)
  v_mfma_f32_16x16x32_bf16 v[16:19], a[192:195], v[128:131], v[16:19]
  v_mfma_f32_16x16x32_bf16 v[20:23], a[196:199], v[128:131], v[20:23]
  v_mfma_f32_16x16x32_bf16 v[24:27], a[200:203], v[128:131], v[24:27]
  buffer_load_dwordx4 v[64:67], v4, s[12:15], s72 offen offset:2048 sc1
  v_mfma_f32_16x16x32_bf16 v[28:31], a[192:195], v[132:135], v[28:31]
  v_mfma_f32_16x16x32_bf16 v[32:35], a[196:199], v[132:135], v[32:35]
  v_mfma_f32_16x16x32_bf16 v[36:39], a[200:203], v[132:135], v[36:39]
  buffer_load_dwordx4 v[80:83], v4, s[12:15], s72 offen offset:3072 sc1
  v_mfma_f32_16x16x32_bf16 v[40:43], a[192:195], v[136:139], v[40:43]
  v_mfma_f32_16x16x32_bf16 v[44:47], a[196:199], v[136:139], v[44:47]
  v_mfma_f32_16x16x32_bf16 v[48:51], a[200:203], v[136:139], v[48:51]
  buffer_load_dwordx4 v[68:71], v4, s[12:15], s73 offen offset:2048 sc1
  v_mfma_f32_16x16x32_bf16 v[52:55], a[192:195], v[140:143], v[52:55]
  v_mfma_f32_16x16x32_bf16 v[56:59], a[196:199], v[140:143], v[56:59]
  v_mfma_f32_16x16x32_bf16 v[60:63], a[200:203], v[140:143], v[60:63]
  buffer_load_dwordx4 v[84:87], v4, s[12:15], s73 offen offset:3072 sc1
  s_waitcnt vmcnt(20)
  v_mfma_f32_16x16x32_bf16 v[16:19], a[204:207], v[144:147], v[16:19]
  v_mfma_f32_16x16x32_bf16 v[20:23], a[208:211], v[144:147], v[20:23]
  v_mfma_f32_16x16x32_bf16 v[24:27], a[212:215], v[144:147], v[24:27]
  buffer_load_dwordx4 v[72:75], v4, s[12:15], s74 offen offset:2048 sc1
  v_mfma_f32_16x16x32_bf16 v[28:31], a[204:207], v[148:151], v[28:31]
  v_mfma_f32_16x16x32_bf16 v[32:35], a[208:211], v[148:151], v[32:35]
  v_mfma_f32_16x16x32_bf16 v[36:39], a[212:215], v[148:151], v[36:39]
  buffer_load_dwordx4 v[88:91], v4, s[12:15], s74 offen offset:3072 sc1
  v_mfma_f32_16x16x32_bf16 v[40:43], a[204:207], v[152:155], v[40:43]
  v_mfma_f32_16x16x32_bf16 v[44:47], a[208:211], v[152:155], v[44:47]
  v_mfma_f32_16x16x32_bf16 v[48:51], a[212:215], v[152:155], v[48:51]
  buffer_load_dwordx4 v[76:79], v4, s[12:15], s75 offen offset:2048 sc1
  v_mfma_f32_16x16x32_bf16 v[52:55], a[204:207], v[156:159], v[52:55]
  v_mfma_f32_16x16x32_bf16 v[56:59], a[208:211], v[156:159], v[56:59]
  v_mfma_f32_16x16x32_bf16 v[60:63], a[212:215], v[156:159], v[60:63]
  buffer_load_dwordx4 v[92:95], v4, s[12:15], s75 offen offset:3072 sc1
  s_waitcnt vmcnt(17)
  v_mfma_f32_16x16x32_bf16 v[16:19], a[216:219], v[160:163], v[16:19]
  v_mfma_f32_16x16x32_bf16 v[20:23], a[220:223], v[160:163], v[20:23]
  v_mfma_f32_16x16x32_bf16 v[24:27], a[224:227], v[160:163], v[24:27]
  v_mfma_f32_16x16x32_bf16 v[28:31], a[216:219], v[164:167], v[28:31]
  v_mfma_f32_16x16x32_bf16 v[32:35], a[220:223], v[164:167], v[32:35]
  v_mfma_f32_16x16x32_bf16 v[36:39], a[224:227], v[164:167], v[36:39]
  v_mfma_f32_16x16x32_bf16 v[40:43], a[216:219], v[168:171], v[40:43]
  v_mfma_f32_16x16x32_bf16 v[44:47], a[220:223], v[168:171], v[44:47]
  v_mfma_f32_16x16x32_bf16 v[48:51], a[224:227], v[168:171], v[48:51]
  v_mfma_f32_16x16x32_bf16 v[52:55], a[216:219], v[172:175], v[52:55]
  v_mfma_f32_16x16x32_bf16 v[56:59], a[220:223], v[172:175], v[56:59]
  v_mfma_f32_16x16x32_bf16 v[60:63], a[224:227], v[172:175], v[60:63]
  v_mul_u32_u24 v6, 768, v2
  v_lshl_add_u32 v6, v3, 3, v6
  v_lshlrev_b32 v7, 4, v3
  v_lshrrev_b32 v12, 1, v3
  v_lshlrev_b32 v12, 8, v12
  v_lshl_add_u32 v12, v2, 4, v12
  v_and_b32 v13, 1, v3
  v_lshl_add_u32 v12, v13, 3, v12
  buffer_load_dwordx2 a[32:33], v12, s[12:15], s25 offen offset:0 sc1
  buffer_load_dwordx2 a[34:35], v12, s[12:15], s25 offen offset:512 sc1
  buffer_load_dwordx2 a[36:37], v12, s[12:15], s25 offen offset:1024 sc1
  buffer_load_dwordx4 a[40:43], v7, s[12:15], s26 offen offset:0 sc1
  buffer_load_dwordx4 a[44:47], v7, s[12:15], s26 offen offset:64 sc1
  buffer_load_dwordx4 a[48:51], v7, s[12:15], s26 offen offset:128 sc1
  s_waitcnt vmcnt(22)
  v_mfma_f32_16x16x32_bf16 v[16:19], a[228:231], v[176:179], v[16:19]
  v_mfma_f32_16x16x32_bf16 v[20:23], a[232:235], v[176:179], v[20:23]
  v_mfma_f32_16x16x32_bf16 v[24:27], a[236:239], v[176:179], v[24:27]
  v_mfma_f32_16x16x32_bf16 v[28:31], a[228:231], v[180:183], v[28:31]
  v_mfma_f32_16x16x32_bf16 v[32:35], a[232:235], v[180:183], v[32:35]
  v_mfma_f32_16x16x32_bf16 v[36:39], a[236:239], v[180:183], v[36:39]
  v_mfma_f32_16x16x32_bf16 v[40:43], a[228:231], v[184:187], v[40:43]
  v_mfma_f32_16x16x32_bf16 v[44:47], a[232:235], v[184:187], v[44:47]
  v_mfma_f32_16x16x32_bf16 v[48:51], a[236:239], v[184:187], v[48:51]
  v_mfma_f32_16x16x32_bf16 v[52:55], a[228:231], v[188:191], v[52:55]
  v_mfma_f32_16x16x32_bf16 v[56:59], a[232:235], v[188:191], v[56:59]
  v_mfma_f32_16x16x32_bf16 v[60:63], a[236:239], v[188:191], v[60:63]
  s_waitcnt vmcnt(15)
  v_mfma_f32_16x16x32_bf16 v[16:19], a[240:243], v[192:195], v[16:19]
  v_mfma_f32_16x16x32_bf16 v[20:23], a[244:247], v[192:195], v[20:23]
  v_mfma_f32_16x16x32_bf16 v[24:27], a[248:251], v[192:195], v[24:27]
  v_mfma_f32_16x16x32_bf16 v[28:31], a[240:243], v[196:199], v[28:31]
  v_mfma_f32_16x16x32_bf16 v[32:35], a[244:247], v[196:199], v[32:35]
  v_mfma_f32_16x16x32_bf16 v[36:39], a[248:251], v[196:199], v[36:39]
  v_mfma_f32_16x16x32_bf16 v[40:43], a[240:243], v[200:203], v[40:43]
  v_mfma_f32_16x16x32_bf16 v[44:47], a[244:247], v[200:203], v[44:47]
  v_mfma_f32_16x16x32_bf16 v[48:51], a[248:251], v[200:203], v[48:51]
  v_mfma_f32_16x16x32_bf16 v[52:55], a[240:243], v[204:207], v[52:55]
  v_mfma_f32_16x16x32_bf16 v[56:59], a[244:247], v[204:207], v[56:59]
  v_mfma_f32_16x16x32_bf16 v[60:63], a[248:251], v[204:207], v[60:63]
  s_waitcnt vmcnt(14)
  v_mfma_f32_16x16x32_bf16 v[16:19], a[252:255], v[208:211], v[16:19]
  v_mfma_f32_16x16x32_bf16 v[20:23], v[224:227], v[208:211], v[20:23]
  v_mfma_f32_16x16x32_bf16 v[24:27], v[228:231], v[208:211], v[24:27]
  v_mfma_f32_16x16x32_bf16 v[28:31], a[252:255], v[212:215], v[28:31]
  v_mfma_f32_16x16x32_bf16 v[32:35], v[224:227], v[212:215], v[32:35]
  v_mfma_f32_16x16x32_bf16 v[36:39], v[228:231], v[212:215], v[36:39]
  v_mfma_f32_16x16x32_bf16 v[40:43], a[252:255], v[216:219], v[40:43]
  v_mfma_f32_16x16x32_bf16 v[44:47], v[224:227], v[216:219], v[44:47]
  v_mfma_f32_16x16x32_bf16 v[48:51], v[228:231], v[216:219], v[48:51]
  v_mfma_f32_16x16x32_bf16 v[52:55], a[252:255], v[220:223], v[52:55]
  v_mfma_f32_16x16x32_bf16 v[56:59], v[224:227], v[220:223], v[56:59]
  v_mfma_f32_16x16x32_bf16 v[60:63], v[228:231], v[220:223], v[60:63]
  s_waitcnt vmcnt(7)
  v_mfma_f32_16x16x32_bf16 v[16:19], v[232:235], v[64:67], v[16:19]
  v_mfma_f32_16x16x32_bf16 v[20:23], v[236:239], v[64:67], v[20:23]
  v_mfma_f32_16x16x32_bf16 v[24:27], v[240:243], v[64:67], v[24:27]
  v_mfma_f32_16x16x32_bf16 v[28:31], v[232:235], v[68:71], v[28:31]
  v_mfma_f32_16x16x32_bf16 v[32:35], v[236:239], v[68:71], v[32:35]
  v_mfma_f32_16x16x32_bf16 v[36:39], v[240:243], v[68:71], v[36:39]
  v_mfma_f32_16x16x32_bf16 v[40:43], v[232:235], v[72:75], v[40:43]
  v_mfma_f32_16x16x32_bf16 v[44:47], v[236:239], v[72:75], v[44:47]
  v_mfma_f32_16x16x32_bf16 v[48:51], v[240:243], v[72:75], v[48:51]
  v_mfma_f32_16x16x32_bf16 v[52:55], v[232:235], v[76:79], v[52:55]
  v_mfma_f32_16x16x32_bf16 v[56:59], v[236:239], v[76:79], v[56:59]
  v_mfma_f32_16x16x32_bf16 v[60:63], v[240:243], v[76:79], v[60:63]
  s_waitcnt vmcnt(6)
  v_mfma_f32_16x16x32_bf16 v[16:19], v[244:247], v[80:83], v[16:19]
  v_mfma_f32_16x16x32_bf16 v[20:23], v[248:251], v[80:83], v[20:23]
  v_mfma_f32_16x16x32_bf16 v[24:27], v[252:255], v[80:83], v[24:27]
  v_mfma_f32_16x16x32_bf16 v[28:31], v[244:247], v[84:87], v[28:31]
  v_mfma_f32_16x16x32_bf16 v[32:35], v[248:251], v[84:87], v[32:35]
  v_mfma_f32_16x16x32_bf16 v[36:39], v[252:255], v[84:87], v[36:39]
  v_mfma_f32_16x16x32_bf16 v[40:43], v[244:247], v[88:91], v[40:43]
  v_mfma_f32_16x16x32_bf16 v[44:47], v[248:251], v[88:91], v[44:47]
  v_mfma_f32_16x16x32_bf16 v[48:51], v[252:255], v[88:91], v[48:51]
  v_mfma_f32_16x16x32_bf16 v[52:55], v[244:247], v[92:95], v[52:55]
  v_mfma_f32_16x16x32_bf16 v[56:59], v[248:251], v[92:95], v[56:59]
  v_mfma_f32_16x16x32_bf16 v[60:63], v[252:255], v[92:95], v[60:63]
  s_waitcnt vmcnt(0)
  s_or_b32 s56, s21, s3
  s_cmp_lg_u32 s56, 0
  s_cbranch_scc1 mega_kernel_nowb
  buffer_wbl2 sc1
mega_kernel_nowb:
  v_accvgpr_read_b32 v128, a32
  v_accvgpr_read_b32 v129, a33
  v_accvgpr_read_b32 v130, a34
  v_accvgpr_read_b32 v131, a35
  v_accvgpr_read_b32 v132, a36
  v_accvgpr_read_b32 v133, a37
  v_accvgpr_read_b32 v136, a40
  v_accvgpr_read_b32 v137, a41
  v_accvgpr_read_b32 v138, a42
  v_accvgpr_read_b32 v139, a43
  v_accvgpr_read_b32 v140, a44
  v_accvgpr_read_b32 v141, a45
  v_accvgpr_read_b32 v142, a46
  v_accvgpr_read_b32 v143, a47
  v_accvgpr_read_b32 v144, a48
  v_accvgpr_read_b32 v145, a49
  v_accvgpr_read_b32 v146, a50
  v_accvgpr_read_b32 v147, a51
  s_mul_i32 s50, s3, 12288
  v_add_u32 v8, s50, v4
  s_mul_i32 s50, s3, 3072
  v_add_u32 v9, s50, v4
  s_nop 4
  ds_write_b128 v8, v[16:19] offset:0
  ds_write_b128 v8, v[20:23] offset:1024
  ds_write_b128 v8, v[24:27] offset:2048
  ds_write_b128 v8, v[28:31] offset:3072
  ds_write_b128 v8, v[32:35] offset:4096
  ds_write_b128 v8, v[36:39] offset:5120
  ds_write_b128 v8, v[40:43] offset:6144
  ds_write_b128 v8, v[44:47] offset:7168
  ds_write_b128 v8, v[48:51] offset:8192
  ds_write_b128 v8, v[52:55] offset:9216
  ds_write_b128 v8, v[56:59] offset:10240
  ds_write_b128 v8, v[60:63] offset:11264
  s_waitcnt lgkmcnt(0)
  s_barrier
  ds_read_b128 v[64:67], v9 offset:0
  ds_read_b128 v[68:71], v9 offset:12288
  ds_read_b128 v[72:75], v9 offset:24576
  ds_read_b128 v[76:79], v9 offset:36864
  ds_read_b128 v[80:83], v9 offset:1024
  ds_read_b128 v[84:87], v9 offset:13312
  ds_read_b128 v[88:91], v9 offset:25600
  ds_read_b128 v[92:95], v9 offset:37888
  ds_read_b128 v[96:99], v9 offset:2048
  ds_read_b128 v[100:103], v9 offset:14336
  ds_read_b128 v[104:107], v9 offset:26624
  ds_read_b128 v[108:111], v9 offset:38912
  v_lshlrev_b32 v112, 16, v128
  v_and_b32 v113, 0xffff0000, v128
  v_lshlrev_b32 v114, 16, v129
  v_and_b32 v115, 0xffff0000, v129
  s_waitcnt lgkmcnt(8)
  v_add_f32 v64, v64, v68
  v_add_f32 v72, v72, v76
  v_add_f32 v65, v65, v69
  v_add_f32 v73, v73, v77
  v_add_f32 v66, v66, v70
  v_add_f32 v74, v74, v78
  v_add_f32 v67, v67, v71
  v_add_f32 v75, v75, v79
  v_add_f32 v64, v64, v72
  v_add_f32 v65, v65, v73
  v_add_f32 v66, v66, v74
  v_add_f32 v67, v67, v75
  v_fma_f32 v64, v64, v136, v112
  v_fma_f32 v65, v65, v137, v113
  v_fma_f32 v66, v66, v138, v114
  v_fma_f32 v67, v67, v139, v115
  v_cvt_pk_bf16_f32 v64, v64, v65
  v_cvt_pk_bf16_f32 v65, v66, v67
  buffer_store_dwordx2 v[64:65], v6, s[16:19], s46 offen offset:0
  v_lshlrev_b32 v112, 16, v130
  v_and_b32 v113, 0xffff0000, v130
  v_lshlrev_b32 v114, 16, v131
  v_and_b32 v115, 0xffff0000, v131
  s_waitcnt lgkmcnt(4)
  v_add_f32 v80, v80, v84
  v_add_f32 v88, v88, v92
  v_add_f32 v81, v81, v85
  v_add_f32 v89, v89, v93
  v_add_f32 v82, v82, v86
  v_add_f32 v90, v90, v94
  v_add_f32 v83, v83, v87
  v_add_f32 v91, v91, v95
  v_add_f32 v80, v80, v88
  v_add_f32 v81, v81, v89
  v_add_f32 v82, v82, v90
  v_add_f32 v83, v83, v91
  v_fma_f32 v80, v80, v140, v112
  v_fma_f32 v81, v81, v141, v113
  v_fma_f32 v82, v82, v142, v114
  v_fma_f32 v83, v83, v143, v115
  v_cvt_pk_bf16_f32 v80, v80, v81
  v_cvt_pk_bf16_f32 v81, v82, v83
  buffer_store_dwordx2 v[80:81], v6, s[16:19], s46 offen offset:32
  v_lshlrev_b32 v112, 16, v132
  v_and_b32 v113, 0xffff0000, v132
  v_lshlrev_b32 v114, 16, v133
  v_and_b32 v115, 0xffff0000, v133
  s_waitcnt lgkmcnt(0)
  v_add_f32 v96, v96, v100
  v_add_f32 v104, v104, v108
  v_add_f32 v97, v97, v101
  v_add_f32 v105, v105, v109
  v_add_f32 v98, v98, v102
  v_add_f32 v106, v106, v110
  v_add_f32 v99, v99, v103
  v_add_f32 v107, v107, v111
  v_add_f32 v96, v96, v104
  v_add_f32 v97, v97, v105
  v_add_f32 v98, v98, v106
  v_add_f32 v99, v99, v107
  v_fma_f32 v96, v96, v144, v112
  v_fma_f32 v97, v97, v145, v113
  v_fma_f32 v98, v98, v146, v114
  v_fma_f32 v99, v99, v147, v115
  v_cvt_pk_bf16_f32 v96, v96, v97
  v_cvt_pk_bf16_f32 v97, v98, v99
  buffer_store_dwordx2 v[96:97], v6, s[16:19], s46 offen offset:64
  s_endpgm
mega_kernel_end:
  s_endpgm
.section .rodata,"a"
.p2align 6
.amdhsa_kernel mega_kernel
  .amdhsa_next_free_vgpr 512
  .amdhsa_next_free_sgpr 102
  .amdhsa_accum_offset 256
  .amdhsa_group_segment_fixed_size 0
  .amdhsa_kernarg_size 80
  .amdhsa_user_sgpr_count 2
  .amdhsa_user_sgpr_kernarg_segment_ptr 1
  .amdhsa_system_sgpr_workgroup_id_x 1
.end_amdhsa_kernel
```
